```python
import torch

def _softmax(x, axis=-1):
    return torch.softmax(x, dim=axis)
def _gelu(x):
    return torch.nn.functional.gelu(x, approximate="tanh")
def _silu(x):
    return torch.nn.functional.silu(x)
def _sigmoid(x):
    return torch.sigmoid(x)
def _layernorm(x, axis=-1, eps=1e-5):
    m = x.mean(dim=axis, keepdim=True)
    v = x.var(dim=axis, keepdim=True, unbiased=False)
    return (x - m) / torch.sqrt(v + eps)
def _scatter_add(tgt, idx, src, axis=0):
    return tgt.clone().index_add_(axis, idx, src)
def _segment_sum(src, seg, n):
    out = torch.zeros((n,) + src.shape[1:], dtype=src.dtype)
    return out.index_add_(0, seg, src)
def _pad(x, pw):
    flat = tuple(v for pair in reversed(pw) for v in pair)
    return torch.nn.functional.pad(x, flat)

kernel_name = 'gated_mix__ssm_conv_h3__dense_activation_squared_relu__prompt'

def setup_inputs():

    _w = (lambda a: (lambda t: t.to(torch.bfloat16) if t.is_floating_point() else t)(torch.as_tensor(a)))
    def _A_setup():
        B, S, D = 1, 2048, 512
        ks = 4
        return {
            "q": _w((lambda *s: torch.randn(*s, dtype=torch.bfloat16) * 0.05)(B, S, D)),
            "k": _w((lambda *s: torch.randn(*s, dtype=torch.bfloat16) * 0.4)(B, S, D)),
            "v": _w((lambda *s: torch.randn(*s, dtype=torch.bfloat16) * 0.4)(B, S, D)),
            "shift_k": _w((lambda *s: torch.randn(*s, dtype=torch.bfloat16) * 0.4)(D, ks) * 0.5),
            "ssm_k": _w((lambda *s: torch.randn(*s, dtype=torch.bfloat16) * 1.6)(D, S) * (1.0 / S ** 0.5)),
            "ssm_D": _w((lambda *s: torch.randn(*s, dtype=torch.bfloat16) * 0.4)(D)),
        }
    _A_in = _A_setup()

    def _B_setup():
        B, S, D, F = 1, 2048, 512, 1792
        return {
            "x": _w((lambda *s: torch.randn(*s, dtype=torch.bfloat16) * 0.05)(B, S, D)),
            "w1": _w((lambda *s: torch.randn(*s, dtype=torch.bfloat16) * 0.05)(D, F)),
            "b1": _w((lambda *s: torch.randn(*s, dtype=torch.bfloat16) * 0.05)(F)),
            "w2": _w((lambda *s: torch.randn(*s, dtype=torch.bfloat16) * 0.05)(F, D)),
            "b2": _w((lambda *s: torch.randn(*s, dtype=torch.bfloat16) * 0.05)(D)),
        }
    _B_in = _B_setup()

    return {
        "A_q": _A_in["q"],
        "A_k": _A_in["k"],
        "A_v": _A_in["v"],
        "A_shift_k": _A_in["shift_k"],
        "A_ssm_k": _A_in["ssm_k"],
        "A_ssm_D": _A_in["ssm_D"],
        "B_x": _B_in["x"],
        "B_w1": _B_in["w1"],
        "B_b1": _B_in["b1"],
        "B_w2": _B_in["w2"],
        "B_b2": _B_in["b2"],
        "gate_w": _w((lambda *s: torch.randn(*s, dtype=torch.bfloat16) * 0.05)(512) * 16.0),
    }

def reference(A_q, A_k, A_v, A_shift_k, A_ssm_k, A_ssm_D, B_x, B_w1, B_b1, B_w2, B_b2, gate_w):
    def _A_ref(q, k, v, shift_k, ssm_k, ssm_D):
        B, S, D = q.shape
        ks = shift_k.shape[-1]
        k_pad = _pad(k, ((0, 0), (ks - 1, 0), (0, 0)))
        k_shift = torch.zeros_like(k)
        for t in range(ks):
            k_shift = k_shift + k_pad[:, t:t + S, :] * shift_k[:, ks - 1 - t][None, None, :]
        kv = k_shift * v
        L = 2 * S
        kv_pad = _pad(kv, ((0, 0), (0, S), (0, 0)))
        kf_pad = _pad(ssm_k, ((0, 0), (0, S)))
        kv_f = (lambda x, axes=(-2,-1): torch.fft.rfft2(x.float(), dim=axes))(kv_pad[:, None, :, :], axes=(1, 2))
        kf_f = (lambda x, axes=(-2,-1): torch.fft.rfft2(x.float(), dim=axes))(kf_pad[:, None, :], axes=(1, 2))
        kf_f = (lambda x, *d: x.permute(*d))(kf_f, 1, 2, 0)
        y_f = kv_f * kf_f[None, :, :, :]
        y = (lambda x, s, axes=(-2,-1): torch.fft.irfft2(x, s=s, dim=axes).to(torch.bfloat16))(y_f, (1, L), axes=(1, 2))[:, 0, :S, :]
        y = y + kv * ssm_D[None, None, :]
        return q * y

    def _B_ref(x, w1, b1, w2, b2):
        h = torch.einsum("bsd,df->bsf", x, w1) + b1
        zero = torch.zeros_like(h)
        r = torch.where(h > zero, h, zero)
        h = r * r
        out = torch.einsum("bsf,fd->bsd", h, w2) + b2
        return out

    x = A_q
    g = _sigmoid((x * gate_w).sum(-1, keepdims=True))
    a = _A_ref(x, A_k, A_v, A_shift_k, A_ssm_k, A_ssm_D)
    b = _B_ref(x, B_w1, B_b1, B_w2, B_b2)
    return g * a + (1 - g) * b
```

```asm
; @launch kernel=kg_kernel grid=(256,1,1) block=(512,1,1) lds=163840
.amdgcn_target "amdgcn-amd-amdhsa--gfx950"
.text
.globl kg_kernel
.p2align 8
.type kg_kernel,@function
kg_kernel:
    s_cmp_ge_u32 s2, 256
    s_cbranch_scc1 L_kg_kernel_end
    v_lshrrev_b32 v1, 6, v0
    s_and_b32 s3, s2, 7
    s_lshr_b32 s4, s2, 3
    v_readfirstlane_b32 s5, v1
    v_and_b32 v1, 63, v0
    v_and_b32 v2, 15, v0
    v_bfe_u32 v3, v0, 4, 2
    v_lshlrev_b32 v4, 4, v1
    s_cmp_ge_u32 s5, 4
    s_cbranch_scc1 L_kg_kernel_aux
    s_load_dwordx2 s[16:17], s[0:1], 8
    s_load_dwordx2 s[20:21], s[0:1], 16
    s_load_dwordx2 s[24:25], s[0:1], 24
    s_load_dwordx2 s[8:9], s[0:1], 0
    s_load_dwordx2 s[12:13], s[0:1], 56
    s_load_dwordx2 s[28:29], s[0:1], 64
    s_load_dwordx2 s[32:33], s[0:1], 112
    s_load_dwordx2 s[36:37], s[0:1], 72
    s_load_dwordx2 s[44:45], s[0:1], 96
    s_load_dwordx2 s[60:61], s[0:1], 104
    v_mov_b32 v30, 163584
    v_lshlrev_b32 v5, 2, v1
    v_add_u32 v5, 163584, v5
    v_mov_b32 v6, 0
    s_cmp_eq_u32 s5, 0
    s_cbranch_scc0 L_kg_kernel_noz
    ds_write_b32 v5, v6
L_kg_kernel_noz:
    s_mov_b32 s10, 2097152
    s_mov_b32 s11, 0x00020000
    s_mov_b32 s14, 1835008
    s_mov_b32 s15, 0x00020000
    s_mov_b32 s18, 2097152
    s_mov_b32 s19, 0x00020000
    s_mov_b32 s22, 2097152
    s_mov_b32 s23, 0x00020000
    s_mov_b32 s26, 4096
    s_mov_b32 s27, 0x00020000
    s_mov_b32 s30, 3584
    s_mov_b32 s31, 0x00020000
    s_mov_b32 s34, 7340032
    s_mov_b32 s35, 0x00020000
    s_mov_b32 s38, 1835008
    s_mov_b32 s39, 0x00020000
    s_mov_b32 s42, 1835008
    s_mov_b32 s43, 0x00020000
    s_mov_b32 s46, 2097152
    s_mov_b32 s47, 0x00020000
    s_mov_b32 s58, 139264
    s_mov_b32 s59, 0x00020000
    s_mov_b32 s62, 256
    s_mov_b32 s63, 0x00020000
    s_and_b32 s6, s3, 3
    s_lshl_b32 s6, s6, 2
    s_and_b32 s7, s4, 3
    s_add_u32 s48, s6, s7
    s_lshr_b32 s6, s3, 2
    s_mul_i32 s6, s6, 7
    s_lshr_b32 s7, s4, 2
    s_add_u32 s49, s6, s7
    s_mov_b32 s54, s3
    s_mul_i32 s50, s5, 5120
    s_add_u32 s50, s50, 131584
    s_lshl_b32 s6, s4, 6
    s_lshl_b32 s7, s5, 4
    s_add_u32 s51, s6, s7
    s_sub_u32 s6, s51, 8
    s_lshl_b32 s6, s6, 10
    s_lshl_b32 s7, s3, 7
    s_add_u32 s6, s6, s7
    v_lshrrev_b32 v5, 3, v1
    v_lshlrev_b32 v5, 10, v5
    v_and_b32 v6, 7, v1
    v_and_b32 v7, 1, v3
    v_lshlrev_b32 v7, 2, v7
    v_xor_b32 v6, v6, v7
    v_lshlrev_b32 v6, 4, v6
    v_add_u32 v5, v5, v6
    v_add_u32 v40, s6, v5
    v_add_u32 v41, 8192, v40
    v_add_u32 v42, 16384, v40
    s_lshl_b32 s6, s3, 6
    v_add_u32 v43, s6, v1
    v_lshlrev_b32 v43, 3, v43
    s_lshl_b32 s6, s48, 7
    s_lshl_b32 s7, s5, 5
    s_add_u32 s6, s6, s7
    s_lshl_b32 s6, s6, 10
    v_lshrrev_b32 v60, 3, v1
    v_and_b32 v61, 7, v1
    v_xor_b32 v61, v61, v60
    v_lshlrev_b32 v61, 4, v61
    v_lshlrev_b32 v60, 10, v60
    v_add_u32 v60, v60, v61
    v_add_u32 v22, s6, v60
    v_add_u32 v23, 7168, v22
    v_add_u32 v24, 14336, v22
    v_add_u32 v25, 21504, v22
    s_lshl_b32 s6, s5, 4
    s_mul_i32 s6, s6, 3584
    s_lshl_b32 s7, s49, 8
    s_add_u32 s6, s6, s7
    v_lshlrev_b32 v62, 1, v3
    v_xor_b32 v62, v62, v2
    v_lshlrev_b32 v62, 4, v62
    v_mul_u32_u24 v63, 3584, v3
    v_add_u32 v62, v62, v63
    v_add_u32 v26, s6, v62
    v_add_u32 v27, 13312, v26
    v_xor_b32 v62, 128, v26
    v_add_u32 v28, 26624, v62
    v_add_u32 v29, 39936, v62
    s_lshl_b32 s55, s5, 12
    s_waitcnt lgkmcnt(0)
    s_add_u32 s40, s32, 14680064
    s_addc_u32 s41, s33, 0
    s_add_u32 s56, s32, 12648448
    s_addc_u32 s57, s33, 0
    s_barrier
    s_cmp_ge_u32 s4, 28
    s_cbranch_scc1 L_kg_kernel_m28
    s_and_b32 s52, s5, 1
    s_lshr_b32 s53, s5, 1
    s_add_u32 s6, s54, 0
    s_and_b32 s6, s6, 7
    s_add_u32 m0, s55, 0
    s_lshl_b32 s7, s6, 7
    buffer_load_dwordx4 v22, s[8:11], s7 offen offset:0 lds
    buffer_load_dwordx4 v23, s[8:11], s7 offen offset:1024 lds
    buffer_load_dwordx4 v24, s[8:11], s7 offen offset:2048 lds
    buffer_load_dwordx4 v25, s[8:11], s7 offen offset:3072 lds
    s_add_u32 m0, s55, 16384
    s_mul_i32 s7, s6, 229376
    buffer_load_dwordx4 v26, s[12:15], s7 offen offset:0 lds
    buffer_load_dwordx4 v27, s[12:15], s7 offen offset:1024 lds
    buffer_load_dwordx4 v28, s[12:15], s7 offen offset:2048 lds
    buffer_load_dwordx4 v29, s[12:15], s7 offen offset:3072 lds
    s_add_u32 m0, s50, 0
    s_nop 0
    buffer_load_dwordx4 v40, s[16:19], 0 offen lds
    s_add_u32 m0, s50, 1024
    s_nop 0
    buffer_load_dwordx4 v41, s[16:19], 0 offen lds
    s_add_u32 m0, s50, 2048
    s_nop 0
    buffer_load_dwordx4 v42, s[16:19], 0 offen lds
    s_add_u32 m0, s50, 3072
    s_nop 0
    buffer_load_dwordx4 v41, s[20:23], 0 offen lds
    s_add_u32 m0, s50, 4096
    s_nop 0
    buffer_load_dwordx4 v42, s[20:23], 0 offen lds
    buffer_load_dwordx2 v[10:11], v43, s[24:27], 0 offen
    s_lshl_b32 s6, s49, 8
    s_lshl_b32 s7, s52, 7
    s_add_u32 s6, s6, s7
    v_lshlrev_b32 v9, 3, v3
    v_add_u32 v9, s6, v9
    buffer_load_dwordx2 v[176:177], v9, s[28:31], 0 offen offset:0
    buffer_load_dwordx2 v[178:179], v9, s[28:31], 0 offen offset:32
    buffer_load_dwordx2 v[180:181], v9, s[28:31], 0 offen offset:64
    buffer_load_dwordx2 v[182:183], v9, s[28:31], 0 offen offset:96
    s_add_u32 s6, s54, 1
    s_and_b32 s6, s6, 7
    s_add_u32 m0, s55, 32768
    s_lshl_b32 s7, s6, 7
    buffer_load_dwordx4 v22, s[8:11], s7 offen offset:0 lds
    buffer_load_dwordx4 v23, s[8:11], s7 offen offset:1024 lds
    buffer_load_dwordx4 v24, s[8:11], s7 offen offset:2048 lds
    buffer_load_dwordx4 v25, s[8:11], s7 offen offset:3072 lds
    s_add_u32 m0, s55, 49152
    s_mul_i32 s7, s6, 229376
    buffer_load_dwordx4 v26, s[12:15], s7 offen offset:0 lds
    buffer_load_dwordx4 v27, s[12:15], s7 offen offset:1024 lds
    buffer_load_dwordx4 v28, s[12:15], s7 offen offset:2048 lds
    buffer_load_dwordx4 v29, s[12:15], s7 offen offset:3072 lds
    s_and_b32 s6, s3, 3
    s_lshl_b32 s6, s6, 3
    s_lshr_b32 s7, s3, 2
    s_lshl_b32 s7, s7, 2
    s_add_u32 s6, s6, s7
    s_and_b32 s7, s4, 3
    s_add_u32 s68, s6, s7
    s_lshr_b32 s69, s4, 2
    s_mul_i32 s6, s5, 14
    s_mul_i32 s7, s69, 56
    s_add_u32 s7, s7, s6
    s_lshl_b32 s7, s7, 12
    v_add_u32 v22, s7, v4
    s_mul_i32 s7, s68, 56
    s_add_u32 s7, s7, s6
    s_lshl_b32 s7, s7, 12
    s_add_u32 s6, s5, 0
    s_and_b32 s6, s6, 3
    s_lshl_b32 s6, s6, 10
    s_add_u32 s6, s6, s7
    v_add_u32 v23, s6, v4
    s_add_u32 s6, s5, 1
    s_and_b32 s6, s6, 3
    s_lshl_b32 s6, s6, 10
    s_add_u32 s6, s6, s7
    v_add_u32 v24, s6, v4
    s_add_u32 s6, s5, 2
    s_and_b32 s6, s6, 3
    s_lshl_b32 s6, s6, 10
    s_add_u32 s6, s6, s7
    v_add_u32 v25, s6, v4
    s_add_u32 s6, s5, 3
    s_and_b32 s6, s6, 3
    s_lshl_b32 s6, s6, 10
    s_add_u32 s6, s6, s7
    v_add_u32 v26, s6, v4
    v_min_u32 v27, 6, v1
    s_mul_i32 s6, s5, 7
    v_add_u32 v27, s6, v27
    v_lshrrev_b32 v28, 1, v27
    v_lshlrev_b32 v28, 7, v28
    v_and_b32 v27, 1, v27
    v_lshlrev_b32 v27, 2, v27
    v_add_u32 v27, v27, v28
    s_lshr_b32 s6, s68, 1
    s_mul_i32 s6, s6, 14
    s_lshl_b32 s6, s6, 7
    s_and_b32 s7, s68, 1
    s_lshl_b32 s7, s7, 3
    s_add_u32 s6, s6, s7
    v_add_u32 v27, s6, v27
    s_lshl_b32 s6, s5, 3
    s_add_u32 s6, s6, s69
    s_lshl_b32 s6, s6, 7
    s_add_u32 s6, s6, 135168
    v_and_b32 v28, 3, v1
    v_lshlrev_b32 v28, 2, v28
    v_add_u32 v28, s6, v28
    v_mov_b32 v29, 0
    s_lshl_b32 s6, s68, 6
    s_lshl_b32 s7, s5, 4
    s_add_u32 s6, s6, s7
    v_add_u32 v5, s6, v2
    v_lshlrev_b32 v5, 10, v5
    v_lshrrev_b32 v6, 1, v3
    v_lshlrev_b32 v6, 4, v6
    v_and_b32 v7, 1, v3
    v_lshlrev_b32 v7, 5, v7
    v_add_u32 v6, v6, v7
    s_lshl_b32 s6, s69, 7
    v_add_u32 v6, s6, v6
    v_add_u32 v5, v5, v6
    s_lshr_b32 s6, s5, 1
    s_mul_i32 s6, s6, 16640
    s_sub_u32 s6, 18688, s6
    s_and_b32 s7, s5, 1
    s_lshl_b32 s7, s7, 13
    s_add_u32 s6, s6, s7
    v_add_u32 v6, s6, v4
    v_lshlrev_b32 v7, 2, v1
    v_add_u32 v7, s6, v7
    s_add_u32 s16, s32, 8388608
    s_addc_u32 s17, s33, 0
    s_mov_b32 s18, 2097152
    s_lshl_b32 s6, s3, 5
    s_add_u32 s6, s6, s4
    s_lshl_b32 s6, s6, 7
    s_lshl_b32 s7, s5, 2
    s_add_u32 s6, s6, s7
    s_add_u32 s20, s6, 32768
    v_lshrrev_b32 v193, 3, v1
    v_and_b32 v194, 7, v1
    v_xor_b32 v195, v194, v193
    v_lshlrev_b32 v195, 4, v195
    v_lshlrev_b32 v192, 7, v193
    v_add_u32 v192, v192, v195
    s_lshl_b32 s6, s5, 11
    s_add_u32 s6, s6, 154368
    v_add_u32 v192, s6, v192
    s_lshl_b32 s6, s3, 6
    s_lshl_b32 s7, s5, 4
    s_add_u32 s6, s6, s7
    s_lshl_b32 s6, s6, 12
    s_lshl_b32 s7, s4, 7
    s_sub_u32 s6, s6, s7
    s_add_u32 s6, s6, 3968
    v_lshlrev_b32 v193, 12, v193
    v_lshlrev_b32 v194, 4, v194
    v_add_u32 v193, v193, v194
    v_add_u32 v193, s6, v193
    v_add_u32 v194, 0x8000, v193
    s_mul_i32 s6, s48, 14
    s_add_u32 s6, s6, s49
    s_lshl_b32 s6, s6, 7
    s_lshl_b32 s7, s5, 2
    s_add_u32 s55, s6, s7
    v_lshrrev_b32 v12, 2, v2
    v_lshlrev_b32 v12, 7, v12
    v_lshlrev_b32 v13, 1, v3
    v_bfe_u32 v14, v2, 1, 1
    v_add_u32 v13, v13, v14
    v_lshrrev_b32 v14, 3, v2
    v_lshlrev_b32 v14, 2, v14
    v_xor_b32 v13, v13, v14
    v_lshlrev_b32 v13, 4, v13
    v_add_u32 v12, v12, v13
    v_and_b32 v13, 1, v2
    v_lshlrev_b32 v13, 3, v13
    v_add_u32 v12, v12, v13
    s_add_u32 s6, s50, 512
    v_add_u32 v44, s6, v12
    s_lshl_b32 s6, s5, 1
    s_sub_u32 s6, 6, s6
    v_and_b32 v12, 7, v1
    v_xor_b32 v12, s6, v12
    v_lshlrev_b32 v12, 4, v12
    v_lshlrev_b32 v13, 7, v1
    v_add_u32 v12, v12, v13
    v_add_u32 v45, 154368, v12
    v_xor_b32 v46, 16, v45
    v_lshrrev_b32 v48, 2, v2
    v_lshlrev_b32 v49, 3, v3
    v_add_u32 v49, v49, v48
    v_lshlrev_b32 v49, 8, v49
    v_and_b32 v50, 1, v3
    v_lshlrev_b32 v50, 2, v50
    v_add_u32 v50, v50, v48
    s_lshl_b32 s6, s52, 2
    v_xor_b32 v50, s6, v50
    v_lshlrev_b32 v50, 5, v50
    v_bfe_u32 v51, v2, 1, 1
    v_lshlrev_b32 v51, 4, v51
    v_and_b32 v52, 1, v2
    v_lshlrev_b32 v52, 3, v52
    v_add_u32 v49, v49, v51
    v_add_u32 v49, v49, v52
    v_xor_b32 v51, 0, v50
    v_add_u32 v32, v49, v51
    v_xor_b32 v51, 32, v50
    v_add_u32 v33, v49, v51
    v_xor_b32 v51, 64, v50
    v_add_u32 v34, v49, v51
    v_xor_b32 v51, 96, v50
    v_add_u32 v35, v49, v51
    v_and_b32 v48, 7, v2
    v_xor_b32 v48, v48, v3
    v_lshlrev_b32 v48, 4, v48
    v_lshlrev_b32 v49, 7, v2
    v_add_u32 v48, v48, v49
    s_lshl_b32 s6, s53, 13
    v_add_u32 v36, s6, v48
    s_lshl_b32 s6, s48, 1
    s_add_u32 s6, s6, s53
    s_mul_i32 s6, s6, 56
    s_lshl_b32 s7, s49, 2
    s_add_u32 s6, s6, s7
    s_lshl_b32 s7, s52, 1
    s_add_u32 s6, s6, s7
    s_lshl_b32 s6, s6, 12
    v_add_u32 v20, s6, v4
    v_add_u32 v21, 4096, v20
    s_waitcnt vmcnt(8)
    v_lshlrev_b32 v160, 16, v176
    v_and_b32 v161, 0xffff0000, v176
    v_lshlrev_b32 v162, 16, v177
    v_and_b32 v163, 0xffff0000, v177
    v_lshlrev_b32 v164, 16, v178
    v_and_b32 v165, 0xffff0000, v178
    v_lshlrev_b32 v166, 16, v179
    v_and_b32 v167, 0xffff0000, v179
    v_lshlrev_b32 v168, 16, v180
    v_and_b32 v169, 0xffff0000, v180
    v_lshlrev_b32 v170, 16, v181
    v_and_b32 v171, 0xffff0000, v181
    v_lshlrev_b32 v172, 16, v182
    v_and_b32 v173, 0xffff0000, v182
    v_lshlrev_b32 v174, 16, v183
    v_and_b32 v175, 0xffff0000, v183
    ds_read_b64_tr_b16 v[64:65], v44 offset:0
    ds_read_b64_tr_b16 v[66:67], v44 offset:512
    ds_read_b64_tr_b16 v[68:69], v44 offset:1024
    ds_read_b64_tr_b16 v[70:71], v44 offset:1536
    ds_read_b64_tr_b16 v[72:73], v44 offset:2048
    ds_read_b64_tr_b16 v[80:81], v44 offset:2560
    ds_read_b64_tr_b16 v[82:83], v44 offset:3072
    ds_read_b64_tr_b16 v[84:85], v44 offset:3584
    ds_read_b64_tr_b16 v[86:87], v44 offset:4096
    v_alignbit_b32 v16, v10, v10, 16
    v_alignbit_b32 v17, v11, v11, 16
    s_waitcnt lgkmcnt(4)
    v_alignbit_b32 v91, v65, v64, 16
    v_alignbit_b32 v92, v66, v65, 16
    v_alignbit_b32 v93, v67, v66, 16
    v_alignbit_b32 v94, v68, v67, 16
    v_alignbit_b32 v95, v69, v68, 16
    v_alignbit_b32 v96, v70, v69, 16
    v_alignbit_b32 v97, v71, v70, 16
    v_alignbit_b32 v98, v72, v71, 16
    v_alignbit_b32 v99, v73, v72, 16
    v_dot2_f32_bf16 v100, v92, v16, 0
    v_dot2_f32_bf16 v101, v66, v16, 0
    v_dot2_f32_bf16 v102, v93, v16, 0
    v_dot2_f32_bf16 v103, v67, v16, 0
    v_dot2_f32_bf16 v104, v94, v16, 0
    v_dot2_f32_bf16 v105, v68, v16, 0
    v_dot2_f32_bf16 v106, v95, v16, 0
    v_dot2_f32_bf16 v107, v69, v16, 0
    v_dot2_f32_bf16 v108, v96, v16, 0
    v_dot2_f32_bf16 v109, v70, v16, 0
    v_dot2_f32_bf16 v110, v97, v16, 0
    v_dot2_f32_bf16 v111, v71, v16, 0
    v_dot2_f32_bf16 v112, v98, v16, 0
    v_dot2_f32_bf16 v113, v72, v16, 0
    v_dot2_f32_bf16 v114, v99, v16, 0
    v_dot2_f32_bf16 v115, v73, v16, 0
    v_dot2_f32_bf16 v100, v91, v17, v100
    v_dot2_f32_bf16 v101, v65, v17, v101
    v_dot2_f32_bf16 v102, v92, v17, v102
    v_dot2_f32_bf16 v103, v66, v17, v103
    v_dot2_f32_bf16 v104, v93, v17, v104
    v_dot2_f32_bf16 v105, v67, v17, v105
    v_dot2_f32_bf16 v106, v94, v17, v106
    v_dot2_f32_bf16 v107, v68, v17, v107
    v_dot2_f32_bf16 v108, v95, v17, v108
    v_dot2_f32_bf16 v109, v69, v17, v109
    v_dot2_f32_bf16 v110, v96, v17, v110
    v_dot2_f32_bf16 v111, v70, v17, v111
    v_dot2_f32_bf16 v112, v97, v17, v112
    v_dot2_f32_bf16 v113, v71, v17, v113
    v_dot2_f32_bf16 v114, v98, v17, v114
    v_dot2_f32_bf16 v115, v72, v17, v115
    s_waitcnt lgkmcnt(0)
    v_lshlrev_b32 v120, 16, v80
    v_and_b32 v121, 0xffff0000, v80
    v_lshlrev_b32 v122, 16, v81
    v_and_b32 v123, 0xffff0000, v81
    v_lshlrev_b32 v124, 16, v82
    v_and_b32 v125, 0xffff0000, v82
    v_lshlrev_b32 v126, 16, v83
    v_and_b32 v127, 0xffff0000, v83
    v_lshlrev_b32 v128, 16, v84
    v_and_b32 v129, 0xffff0000, v84
    v_lshlrev_b32 v130, 16, v85
    v_and_b32 v131, 0xffff0000, v85
    v_lshlrev_b32 v132, 16, v86
    v_and_b32 v133, 0xffff0000, v86
    v_lshlrev_b32 v134, 16, v87
    v_and_b32 v135, 0xffff0000, v87
    v_mul_f32 v100, v100, v120
    v_mul_f32 v101, v101, v121
    v_mul_f32 v102, v102, v122
    v_mul_f32 v103, v103, v123
    v_mul_f32 v104, v104, v124
    v_mul_f32 v105, v105, v125
    v_mul_f32 v106, v106, v126
    v_mul_f32 v107, v107, v127
    v_mul_f32 v108, v108, v128
    v_mul_f32 v109, v109, v129
    v_mul_f32 v110, v110, v130
    v_mul_f32 v111, v111, v131
    v_mul_f32 v112, v112, v132
    v_mul_f32 v113, v113, v133
    v_mul_f32 v114, v114, v134
    v_mul_f32 v115, v115, v135
    v_cvt_pk_bf16_f32 v140, v115, v114
    v_cvt_pk_bf16_f32 v141, v113, v112
    v_cvt_pk_bf16_f32 v142, v111, v110
    v_cvt_pk_bf16_f32 v143, v109, v108
    v_cvt_pk_bf16_f32 v144, v107, v106
    v_cvt_pk_bf16_f32 v145, v105, v104
    v_cvt_pk_bf16_f32 v146, v103, v102
    v_cvt_pk_bf16_f32 v147, v101, v100
    ds_write_b128 v45, v[140:143]
    ds_write_b128 v46, v[144:147]
    s_waitcnt lgkmcnt(0)
    v_mov_b32 v31, 1
    s_mov_b64 exec, 1
    ds_add_u32 v30, v31 offset:8
    s_mov_b64 exec, -1
    v_mov_b32 v8, v32
    v_add_u32 v12, 0x10000, v32
    v_mov_b32 v9, v33
    v_add_u32 v13, 0x10000, v33
    v_mov_b32 v10, v34
    v_add_u32 v14, 0x10000, v34
    v_mov_b32 v11, v35
    v_add_u32 v15, 0x10000, v35
    v_mov_b32 v16, v36
    v_xor_b32 v17, 64, v36
    v_add_u32 v18, 0x10000, v36
    v_add_u32 v19, 0x10000, v17
    v_mov_b32 v31, 1
    s_mov_b64 exec, 1
    ds_add_u32 v30, v31 offset:0
    s_mov_b64 exec, -1
    s_mov_b32 s68, 0
L_kg_kernel_m0:
    ds_read_b32 v31, v30 offset:0
    s_waitcnt lgkmcnt(0)
    v_readfirstlane_b32 s69, v31
    s_cmp_ge_u32 s69, 4
    s_cbranch_scc1 L_kg_kernel_m0_ok
    s_add_u32 s68, s68, 1
    s_cmp_lt_u32 s68, 3200000
    s_cbranch_scc1 L_kg_kernel_m0
L_kg_kernel_m0_ok:
    ds_read_b128 v[196:199], v192
    ds_read_b128 v[200:203], v192 offset:1024
    ds_read_b128 v[112:115], v16 offset:0
    ds_read_b64_tr_b16 v[96:97], v8 offset:16384
    ds_read_b64_tr_b16 v[98:99], v8 offset:17408
    ds_read_b128 v[116:119], v16 offset:2048
    ds_read_b128 v[120:123], v16 offset:4096
    ds_read_b128 v[124:127], v16 offset:6144
    ds_read_b64_tr_b16 v[100:101], v9 offset:16384
    ds_read_b64_tr_b16 v[102:103], v9 offset:17408
    ds_read_b64_tr_b16 v[104:105], v10 offset:16384
    ds_read_b64_tr_b16 v[106:107], v10 offset:17408
    ds_read_b64_tr_b16 v[108:109], v11 offset:16384
    ds_read_b64_tr_b16 v[110:111], v11 offset:17408
    s_waitcnt lgkmcnt(0)
    buffer_load_dword v185, v29, s[60:63], 0 offen sc1
    buffer_store_dwordx4 v[196:199], v193, s[16:19], 0 offen sc1
    buffer_store_dwordx4 v[200:203], v194, s[16:19], 0 offen sc1
    v_mov_b32 v31, 1
    s_mov_b64 exec, 1
    ds_add_u32 v30, v31 offset:20
    s_mov_b64 exec, -1
    v_mfma_f32_16x16x32_bf16 v[32:35], v[96:99], v[112:115], v[160:163]
    ds_read_b128 v[144:147], v17 offset:0
    v_mfma_f32_16x16x32_bf16 v[36:39], v[96:99], v[116:119], v[160:163]
    ds_read_b64_tr_b16 v[128:129], v8 offset:24576
    v_mfma_f32_16x16x32_bf16 v[40:43], v[96:99], v[120:123], v[160:163]
    ds_read_b64_tr_b16 v[130:131], v8 offset:25600
    v_mfma_f32_16x16x32_bf16 v[44:47], v[96:99], v[124:127], v[160:163]
    ds_read_b128 v[148:151], v17 offset:2048
    v_mfma_f32_16x16x32_bf16 v[48:51], v[100:103], v[112:115], v[164:167]
    ds_read_b128 v[152:155], v17 offset:4096
    v_mfma_f32_16x16x32_bf16 v[52:55], v[100:103], v[116:119], v[164:167]
    ds_read_b128 v[156:159], v17 offset:6144
    v_mfma_f32_16x16x32_bf16 v[56:59], v[100:103], v[120:123], v[164:167]
    ds_read_b64_tr_b16 v[132:133], v9 offset:24576
    v_mfma_f32_16x16x32_bf16 v[60:63], v[100:103], v[124:127], v[164:167]
    ds_read_b64_tr_b16 v[134:135], v9 offset:25600
    v_mfma_f32_16x16x32_bf16 v[64:67], v[104:107], v[112:115], v[168:171]
    ds_read_b64_tr_b16 v[136:137], v10 offset:24576
    v_mfma_f32_16x16x32_bf16 v[68:71], v[104:107], v[116:119], v[168:171]
    ds_read_b64_tr_b16 v[138:139], v10 offset:25600
    v_mfma_f32_16x16x32_bf16 v[72:75], v[104:107], v[120:123], v[168:171]
    ds_read_b64_tr_b16 v[140:141], v11 offset:24576
    v_mfma_f32_16x16x32_bf16 v[76:79], v[104:107], v[124:127], v[168:171]
    ds_read_b64_tr_b16 v[142:143], v11 offset:25600
    v_mfma_f32_16x16x32_bf16 v[80:83], v[108:111], v[112:115], v[172:175]
    v_mfma_f32_16x16x32_bf16 v[84:87], v[108:111], v[116:119], v[172:175]
    v_mfma_f32_16x16x32_bf16 v[88:91], v[108:111], v[120:123], v[172:175]
    v_mfma_f32_16x16x32_bf16 v[92:95], v[108:111], v[124:127], v[172:175]
    s_waitcnt lgkmcnt(0)
    s_waitcnt vmcnt(3)
    v_mov_b32 v31, 1
    s_mov_b64 exec, 1
    ds_add_u32 v30, v31 offset:4
    s_mov_b64 exec, -1
    s_mov_b32 s68, 0
L_kg_kernel_m1:
    ds_read_b32 v31, v30 offset:4
    s_waitcnt lgkmcnt(0)
    v_readfirstlane_b32 s69, v31
    s_cmp_ge_u32 s69, 4
    s_cbranch_scc1 L_kg_kernel_m1_ok
    s_add_u32 s68, s68, 1
    s_cmp_lt_u32 s68, 3200000
    s_cbranch_scc1 L_kg_kernel_m1
L_kg_kernel_m1_ok:
    v_mfma_f32_16x16x32_bf16 v[32:35], v[128:131], v[144:147], v[32:35]
    ds_read_b128 v[112:115], v16 offset:32768
    v_mfma_f32_16x16x32_bf16 v[36:39], v[128:131], v[148:151], v[36:39]
    ds_read_b64_tr_b16 v[96:97], v8 offset:49152
    v_mfma_f32_16x16x32_bf16 v[40:43], v[128:131], v[152:155], v[40:43]
    ds_read_b64_tr_b16 v[98:99], v8 offset:50176
    v_mfma_f32_16x16x32_bf16 v[44:47], v[128:131], v[156:159], v[44:47]
    ds_read_b128 v[116:119], v16 offset:34816
    v_mfma_f32_16x16x32_bf16 v[48:51], v[132:135], v[144:147], v[48:51]
    ds_read_b128 v[120:123], v16 offset:36864
    v_mfma_f32_16x16x32_bf16 v[52:55], v[132:135], v[148:151], v[52:55]
    ds_read_b128 v[124:127], v16 offset:38912
    v_mfma_f32_16x16x32_bf16 v[56:59], v[132:135], v[152:155], v[56:59]
    ds_read_b64_tr_b16 v[100:101], v9 offset:49152
    v_mfma_f32_16x16x32_bf16 v[60:63], v[132:135], v[156:159], v[60:63]
    ds_read_b64_tr_b16 v[102:103], v9 offset:50176
    v_mfma_f32_16x16x32_bf16 v[64:67], v[136:139], v[144:147], v[64:67]
    ds_read_b64_tr_b16 v[104:105], v10 offset:49152
    v_mfma_f32_16x16x32_bf16 v[68:71], v[136:139], v[148:151], v[68:71]
    ds_read_b64_tr_b16 v[106:107], v10 offset:50176
    v_mfma_f32_16x16x32_bf16 v[72:75], v[136:139], v[152:155], v[72:75]
    ds_read_b64_tr_b16 v[108:109], v11 offset:49152
    v_mfma_f32_16x16x32_bf16 v[76:79], v[136:139], v[156:159], v[76:79]
    ds_read_b64_tr_b16 v[110:111], v11 offset:50176
    v_mfma_f32_16x16x32_bf16 v[80:83], v[140:143], v[144:147], v[80:83]
    v_mfma_f32_16x16x32_bf16 v[84:87], v[140:143], v[148:151], v[84:87]
    v_mfma_f32_16x16x32_bf16 v[88:91], v[140:143], v[152:155], v[88:91]
    v_mfma_f32_16x16x32_bf16 v[92:95], v[140:143], v[156:159], v[92:95]
    s_waitcnt lgkmcnt(0)
    v_mfma_f32_16x16x32_bf16 v[32:35], v[96:99], v[112:115], v[32:35]
    ds_read_b128 v[144:147], v17 offset:32768
    v_mfma_f32_16x16x32_bf16 v[36:39], v[96:99], v[116:119], v[36:39]
    ds_read_b64_tr_b16 v[128:129], v8 offset:57344
    v_mfma_f32_16x16x32_bf16 v[40:43], v[96:99], v[120:123], v[40:43]
    ds_read_b64_tr_b16 v[130:131], v8 offset:58368
    v_mfma_f32_16x16x32_bf16 v[44:47], v[96:99], v[124:127], v[44:47]
    ds_read_b128 v[148:151], v17 offset:34816
    v_mfma_f32_16x16x32_bf16 v[48:51], v[100:103], v[112:115], v[48:51]
    ds_read_b128 v[152:155], v17 offset:36864
    v_mfma_f32_16x16x32_bf16 v[52:55], v[100:103], v[116:119], v[52:55]
    ds_read_b128 v[156:159], v17 offset:38912
    v_mfma_f32_16x16x32_bf16 v[56:59], v[100:103], v[120:123], v[56:59]
    ds_read_b64_tr_b16 v[132:133], v9 offset:57344
    v_mfma_f32_16x16x32_bf16 v[60:63], v[100:103], v[124:127], v[60:63]
    ds_read_b64_tr_b16 v[134:135], v9 offset:58368
    v_mfma_f32_16x16x32_bf16 v[64:67], v[104:107], v[112:115], v[64:67]
    ds_read_b64_tr_b16 v[136:137], v10 offset:57344
    v_mfma_f32_16x16x32_bf16 v[68:71], v[104:107], v[116:119], v[68:71]
    ds_read_b64_tr_b16 v[138:139], v10 offset:58368
    v_mfma_f32_16x16x32_bf16 v[72:75], v[104:107], v[120:123], v[72:75]
    ds_read_b64_tr_b16 v[140:141], v11 offset:57344
    v_mfma_f32_16x16x32_bf16 v[76:79], v[104:107], v[124:127], v[76:79]
    ds_read_b64_tr_b16 v[142:143], v11 offset:58368
    v_mfma_f32_16x16x32_bf16 v[80:83], v[108:111], v[112:115], v[80:83]
    v_mfma_f32_16x16x32_bf16 v[84:87], v[108:111], v[116:119], v[84:87]
    v_mfma_f32_16x16x32_bf16 v[88:91], v[108:111], v[120:123], v[88:91]
    v_mfma_f32_16x16x32_bf16 v[92:95], v[108:111], v[124:127], v[92:95]
    s_waitcnt lgkmcnt(0)
    s_waitcnt vmcnt(0)
    v_readfirstlane_b32 s54, v185
    s_cmp_lg_u32 s54, 0
    s_cbranch_scc1 L_kg_kernel_nma_ok
    s_mov_b32 s68, 0
L_kg_kernel_nma:
    buffer_load_dword v185, v29, s[60:63], 0 offen sc1
    s_waitcnt vmcnt(0)
    v_readfirstlane_b32 s54, v185
    s_cmp_lg_u32 s54, 0
    s_cbranch_scc1 L_kg_kernel_nma_ok
    s_add_u32 s68, s68, 1
    s_cmp_lt_u32 s68, 200000
    s_cbranch_scc1 L_kg_kernel_nma
L_kg_kernel_nma_ok:
    v_mov_b32 v31, s54
    s_mov_b64 exec, 1
    buffer_store_dword v31, v29, s[56:59], s20 offen sc1
    s_mov_b64 exec, -1
    s_barrier
    v_mfma_f32_16x16x32_bf16 v[32:35], v[128:131], v[144:147], v[32:35]
    ds_read_b128 v[112:115], v18 offset:0
    v_mfma_f32_16x16x32_bf16 v[36:39], v[128:131], v[148:151], v[36:39]
    ds_read_b64_tr_b16 v[96:97], v12 offset:16384
    v_mfma_f32_16x16x32_bf16 v[40:43], v[128:131], v[152:155], v[40:43]
    ds_read_b64_tr_b16 v[98:99], v12 offset:17408
    v_mfma_f32_16x16x32_bf16 v[44:47], v[128:131], v[156:159], v[44:47]
    ds_read_b128 v[116:119], v18 offset:2048
    v_mfma_f32_16x16x32_bf16 v[48:51], v[132:135], v[144:147], v[48:51]
    ds_read_b128 v[120:123], v18 offset:4096
    v_mfma_f32_16x16x32_bf16 v[52:55], v[132:135], v[148:151], v[52:55]
    ds_read_b128 v[124:127], v18 offset:6144
    v_mfma_f32_16x16x32_bf16 v[56:59], v[132:135], v[152:155], v[56:59]
    ds_read_b64_tr_b16 v[100:101], v13 offset:16384
    v_mfma_f32_16x16x32_bf16 v[60:63], v[132:135], v[156:159], v[60:63]
    ds_read_b64_tr_b16 v[102:103], v13 offset:17408
    v_mfma_f32_16x16x32_bf16 v[64:67], v[136:139], v[144:147], v[64:67]
    ds_read_b64_tr_b16 v[104:105], v14 offset:16384
    v_mfma_f32_16x16x32_bf16 v[68:71], v[136:139], v[148:151], v[68:71]
    ds_read_b64_tr_b16 v[106:107], v14 offset:17408
    v_mfma_f32_16x16x32_bf16 v[72:75], v[136:139], v[152:155], v[72:75]
    ds_read_b64_tr_b16 v[108:109], v15 offset:16384
    v_mfma_f32_16x16x32_bf16 v[76:79], v[136:139], v[156:159], v[76:79]
    ds_read_b64_tr_b16 v[110:111], v15 offset:17408
    v_mfma_f32_16x16x32_bf16 v[80:83], v[140:143], v[144:147], v[80:83]
    v_mfma_f32_16x16x32_bf16 v[84:87], v[140:143], v[148:151], v[84:87]
    v_mfma_f32_16x16x32_bf16 v[88:91], v[140:143], v[152:155], v[88:91]
    v_mfma_f32_16x16x32_bf16 v[92:95], v[140:143], v[156:159], v[92:95]
    s_waitcnt lgkmcnt(0)
    v_mfma_f32_16x16x32_bf16 v[32:35], v[96:99], v[112:115], v[32:35]
    ds_read_b128 v[144:147], v19 offset:0
    v_mfma_f32_16x16x32_bf16 v[36:39], v[96:99], v[116:119], v[36:39]
    ds_read_b64_tr_b16 v[128:129], v12 offset:24576
    v_mfma_f32_16x16x32_bf16 v[40:43], v[96:99], v[120:123], v[40:43]
    ds_read_b64_tr_b16 v[130:131], v12 offset:25600
    v_mfma_f32_16x16x32_bf16 v[44:47], v[96:99], v[124:127], v[44:47]
    ds_read_b128 v[148:151], v19 offset:2048
    v_mfma_f32_16x16x32_bf16 v[48:51], v[100:103], v[112:115], v[48:51]
    ds_read_b128 v[152:155], v19 offset:4096
    v_mfma_f32_16x16x32_bf16 v[52:55], v[100:103], v[116:119], v[52:55]
    ds_read_b128 v[156:159], v19 offset:6144
    v_mfma_f32_16x16x32_bf16 v[56:59], v[100:103], v[120:123], v[56:59]
    ds_read_b64_tr_b16 v[132:133], v13 offset:24576
    v_mfma_f32_16x16x32_bf16 v[60:63], v[100:103], v[124:127], v[60:63]
    ds_read_b64_tr_b16 v[134:135], v13 offset:25600
    v_mfma_f32_16x16x32_bf16 v[64:67], v[104:107], v[112:115], v[64:67]
    ds_read_b64_tr_b16 v[136:137], v14 offset:24576
    v_mfma_f32_16x16x32_bf16 v[68:71], v[104:107], v[116:119], v[68:71]
    ds_read_b64_tr_b16 v[138:139], v14 offset:25600
    v_mfma_f32_16x16x32_bf16 v[72:75], v[104:107], v[120:123], v[72:75]
    ds_read_b64_tr_b16 v[140:141], v15 offset:24576
    v_mfma_f32_16x16x32_bf16 v[76:79], v[104:107], v[124:127], v[76:79]
    ds_read_b64_tr_b16 v[142:143], v15 offset:25600
    v_mfma_f32_16x16x32_bf16 v[80:83], v[108:111], v[112:115], v[80:83]
    v_mfma_f32_16x16x32_bf16 v[84:87], v[108:111], v[116:119], v[84:87]
    v_mfma_f32_16x16x32_bf16 v[88:91], v[108:111], v[120:123], v[88:91]
    v_mfma_f32_16x16x32_bf16 v[92:95], v[108:111], v[124:127], v[92:95]
    s_waitcnt lgkmcnt(0)
    s_barrier
    v_mfma_f32_16x16x32_bf16 v[32:35], v[128:131], v[144:147], v[32:35]
    ds_read_b128 v[112:115], v18 offset:32768
    v_mfma_f32_16x16x32_bf16 v[36:39], v[128:131], v[148:151], v[36:39]
    ds_read_b64_tr_b16 v[96:97], v12 offset:49152
    v_mfma_f32_16x16x32_bf16 v[40:43], v[128:131], v[152:155], v[40:43]
    ds_read_b64_tr_b16 v[98:99], v12 offset:50176
    v_mfma_f32_16x16x32_bf16 v[44:47], v[128:131], v[156:159], v[44:47]
    ds_read_b128 v[116:119], v18 offset:34816
    v_mfma_f32_16x16x32_bf16 v[48:51], v[132:135], v[144:147], v[48:51]
    ds_read_b128 v[120:123], v18 offset:36864
    v_mfma_f32_16x16x32_bf16 v[52:55], v[132:135], v[148:151], v[52:55]
    ds_read_b128 v[124:127], v18 offset:38912
    v_mfma_f32_16x16x32_bf16 v[56:59], v[132:135], v[152:155], v[56:59]
    ds_read_b64_tr_b16 v[100:101], v13 offset:49152
    v_mfma_f32_16x16x32_bf16 v[60:63], v[132:135], v[156:159], v[60:63]
    ds_read_b64_tr_b16 v[102:103], v13 offset:50176
    v_mfma_f32_16x16x32_bf16 v[64:67], v[136:139], v[144:147], v[64:67]
    ds_read_b64_tr_b16 v[104:105], v14 offset:49152
    v_mfma_f32_16x16x32_bf16 v[68:71], v[136:139], v[148:151], v[68:71]
    ds_read_b64_tr_b16 v[106:107], v14 offset:50176
    v_mfma_f32_16x16x32_bf16 v[72:75], v[136:139], v[152:155], v[72:75]
    ds_read_b64_tr_b16 v[108:109], v15 offset:49152
    v_mfma_f32_16x16x32_bf16 v[76:79], v[136:139], v[156:159], v[76:79]
    ds_read_b64_tr_b16 v[110:111], v15 offset:50176
    v_mfma_f32_16x16x32_bf16 v[80:83], v[140:143], v[144:147], v[80:83]
    v_mfma_f32_16x16x32_bf16 v[84:87], v[140:143], v[148:151], v[84:87]
    v_mfma_f32_16x16x32_bf16 v[88:91], v[140:143], v[152:155], v[88:91]
    v_mfma_f32_16x16x32_bf16 v[92:95], v[140:143], v[156:159], v[92:95]
    s_waitcnt lgkmcnt(0)
    v_mfma_f32_16x16x32_bf16 v[32:35], v[96:99], v[112:115], v[32:35]
    ds_read_b128 v[144:147], v19 offset:32768
    v_mfma_f32_16x16x32_bf16 v[36:39], v[96:99], v[116:119], v[36:39]
    ds_read_b64_tr_b16 v[128:129], v12 offset:57344
    v_mfma_f32_16x16x32_bf16 v[40:43], v[96:99], v[120:123], v[40:43]
    ds_read_b64_tr_b16 v[130:131], v12 offset:58368
    v_mfma_f32_16x16x32_bf16 v[44:47], v[96:99], v[124:127], v[44:47]
    ds_read_b128 v[148:151], v19 offset:34816
    v_mfma_f32_16x16x32_bf16 v[48:51], v[100:103], v[112:115], v[48:51]
    ds_read_b128 v[152:155], v19 offset:36864
    v_mfma_f32_16x16x32_bf16 v[52:55], v[100:103], v[116:119], v[52:55]
    ds_read_b128 v[156:159], v19 offset:38912
    v_mfma_f32_16x16x32_bf16 v[56:59], v[100:103], v[120:123], v[56:59]
    ds_read_b64_tr_b16 v[132:133], v13 offset:57344
    v_mfma_f32_16x16x32_bf16 v[60:63], v[100:103], v[124:127], v[60:63]
    ds_read_b64_tr_b16 v[134:135], v13 offset:58368
    v_mfma_f32_16x16x32_bf16 v[64:67], v[104:107], v[112:115], v[64:67]
    ds_read_b64_tr_b16 v[136:137], v14 offset:57344
    v_mfma_f32_16x16x32_bf16 v[68:71], v[104:107], v[116:119], v[68:71]
    ds_read_b64_tr_b16 v[138:139], v14 offset:58368
    v_mfma_f32_16x16x32_bf16 v[72:75], v[104:107], v[120:123], v[72:75]
    ds_read_b64_tr_b16 v[140:141], v15 offset:57344
    v_mfma_f32_16x16x32_bf16 v[76:79], v[104:107], v[124:127], v[76:79]
    ds_read_b64_tr_b16 v[142:143], v15 offset:58368
    v_mfma_f32_16x16x32_bf16 v[80:83], v[108:111], v[112:115], v[80:83]
    v_mfma_f32_16x16x32_bf16 v[84:87], v[108:111], v[116:119], v[84:87]
    v_mfma_f32_16x16x32_bf16 v[88:91], v[108:111], v[120:123], v[88:91]
    v_mfma_f32_16x16x32_bf16 v[92:95], v[108:111], v[124:127], v[92:95]
    s_waitcnt lgkmcnt(0)
    s_barrier
    v_mfma_f32_16x16x32_bf16 v[32:35], v[128:131], v[144:147], v[32:35]
    ds_read_b128 v[112:115], v16 offset:0
    v_mfma_f32_16x16x32_bf16 v[36:39], v[128:131], v[148:151], v[36:39]
    ds_read_b64_tr_b16 v[96:97], v8 offset:16384
    v_mfma_f32_16x16x32_bf16 v[40:43], v[128:131], v[152:155], v[40:43]
    ds_read_b64_tr_b16 v[98:99], v8 offset:17408
    v_mfma_f32_16x16x32_bf16 v[44:47], v[128:131], v[156:159], v[44:47]
    ds_read_b128 v[116:119], v16 offset:2048
    v_mfma_f32_16x16x32_bf16 v[48:51], v[132:135], v[144:147], v[48:51]
    ds_read_b128 v[120:123], v16 offset:4096
    v_mfma_f32_16x16x32_bf16 v[52:55], v[132:135], v[148:151], v[52:55]
    ds_read_b128 v[124:127], v16 offset:6144
    v_mfma_f32_16x16x32_bf16 v[56:59], v[132:135], v[152:155], v[56:59]
    ds_read_b64_tr_b16 v[100:101], v9 offset:16384
    v_mfma_f32_16x16x32_bf16 v[60:63], v[132:135], v[156:159], v[60:63]
    ds_read_b64_tr_b16 v[102:103], v9 offset:17408
    v_mfma_f32_16x16x32_bf16 v[64:67], v[136:139], v[144:147], v[64:67]
    ds_read_b64_tr_b16 v[104:105], v10 offset:16384
    v_mfma_f32_16x16x32_bf16 v[68:71], v[136:139], v[148:151], v[68:71]
    ds_read_b64_tr_b16 v[106:107], v10 offset:17408
    v_mfma_f32_16x16x32_bf16 v[72:75], v[136:139], v[152:155], v[72:75]
    ds_read_b64_tr_b16 v[108:109], v11 offset:16384
    v_mfma_f32_16x16x32_bf16 v[76:79], v[136:139], v[156:159], v[76:79]
    ds_read_b64_tr_b16 v[110:111], v11 offset:17408
    v_mfma_f32_16x16x32_bf16 v[80:83], v[140:143], v[144:147], v[80:83]
    v_mfma_f32_16x16x32_bf16 v[84:87], v[140:143], v[148:151], v[84:87]
    v_mfma_f32_16x16x32_bf16 v[88:91], v[140:143], v[152:155], v[88:91]
    v_mfma_f32_16x16x32_bf16 v[92:95], v[140:143], v[156:159], v[92:95]
    s_waitcnt lgkmcnt(0)
    v_mfma_f32_16x16x32_bf16 v[32:35], v[96:99], v[112:115], v[32:35]
    ds_read_b128 v[144:147], v17 offset:0
    v_mfma_f32_16x16x32_bf16 v[36:39], v[96:99], v[116:119], v[36:39]
    ds_read_b64_tr_b16 v[128:129], v8 offset:24576
    v_mfma_f32_16x16x32_bf16 v[40:43], v[96:99], v[120:123], v[40:43]
    ds_read_b64_tr_b16 v[130:131], v8 offset:25600
    v_mfma_f32_16x16x32_bf16 v[44:47], v[96:99], v[124:127], v[44:47]
    ds_read_b128 v[148:151], v17 offset:2048
    v_mfma_f32_16x16x32_bf16 v[48:51], v[100:103], v[112:115], v[48:51]
    ds_read_b128 v[152:155], v17 offset:4096
    v_mfma_f32_16x16x32_bf16 v[52:55], v[100:103], v[116:119], v[52:55]
    ds_read_b128 v[156:159], v17 offset:6144
    v_mfma_f32_16x16x32_bf16 v[56:59], v[100:103], v[120:123], v[56:59]
    ds_read_b64_tr_b16 v[132:133], v9 offset:24576
    v_mfma_f32_16x16x32_bf16 v[60:63], v[100:103], v[124:127], v[60:63]
    ds_read_b64_tr_b16 v[134:135], v9 offset:25600
    v_mfma_f32_16x16x32_bf16 v[64:67], v[104:107], v[112:115], v[64:67]
    ds_read_b64_tr_b16 v[136:137], v10 offset:24576
    v_mfma_f32_16x16x32_bf16 v[68:71], v[104:107], v[116:119], v[68:71]
    ds_read_b64_tr_b16 v[138:139], v10 offset:25600
    v_mfma_f32_16x16x32_bf16 v[72:75], v[104:107], v[120:123], v[72:75]
    ds_read_b64_tr_b16 v[140:141], v11 offset:24576
    v_mfma_f32_16x16x32_bf16 v[76:79], v[104:107], v[124:127], v[76:79]
    ds_read_b64_tr_b16 v[142:143], v11 offset:25600
    v_mfma_f32_16x16x32_bf16 v[80:83], v[108:111], v[112:115], v[80:83]
    v_mfma_f32_16x16x32_bf16 v[84:87], v[108:111], v[116:119], v[84:87]
    v_mfma_f32_16x16x32_bf16 v[88:91], v[108:111], v[120:123], v[88:91]
    v_mfma_f32_16x16x32_bf16 v[92:95], v[108:111], v[124:127], v[92:95]
    s_waitcnt lgkmcnt(0)
    s_barrier
    v_mfma_f32_16x16x32_bf16 v[32:35], v[128:131], v[144:147], v[32:35]
    ds_read_b128 v[112:115], v16 offset:32768
    v_mfma_f32_16x16x32_bf16 v[36:39], v[128:131], v[148:151], v[36:39]
    ds_read_b64_tr_b16 v[96:97], v8 offset:49152
    v_mfma_f32_16x16x32_bf16 v[40:43], v[128:131], v[152:155], v[40:43]
    ds_read_b64_tr_b16 v[98:99], v8 offset:50176
    v_mfma_f32_16x16x32_bf16 v[44:47], v[128:131], v[156:159], v[44:47]
    ds_read_b128 v[116:119], v16 offset:34816
    v_mfma_f32_16x16x32_bf16 v[48:51], v[132:135], v[144:147], v[48:51]
    ds_read_b128 v[120:123], v16 offset:36864
    v_mfma_f32_16x16x32_bf16 v[52:55], v[132:135], v[148:151], v[52:55]
    ds_read_b128 v[124:127], v16 offset:38912
    v_mfma_f32_16x16x32_bf16 v[56:59], v[132:135], v[152:155], v[56:59]
    ds_read_b64_tr_b16 v[100:101], v9 offset:49152
    v_mfma_f32_16x16x32_bf16 v[60:63], v[132:135], v[156:159], v[60:63]
    ds_read_b64_tr_b16 v[102:103], v9 offset:50176
    v_mfma_f32_16x16x32_bf16 v[64:67], v[136:139], v[144:147], v[64:67]
    ds_read_b64_tr_b16 v[104:105], v10 offset:49152
    v_mfma_f32_16x16x32_bf16 v[68:71], v[136:139], v[148:151], v[68:71]
    ds_read_b64_tr_b16 v[106:107], v10 offset:50176
    v_mfma_f32_16x16x32_bf16 v[72:75], v[136:139], v[152:155], v[72:75]
    ds_read_b64_tr_b16 v[108:109], v11 offset:49152
    v_mfma_f32_16x16x32_bf16 v[76:79], v[136:139], v[156:159], v[76:79]
    ds_read_b64_tr_b16 v[110:111], v11 offset:50176
    v_mfma_f32_16x16x32_bf16 v[80:83], v[140:143], v[144:147], v[80:83]
    v_mfma_f32_16x16x32_bf16 v[84:87], v[140:143], v[148:151], v[84:87]
    v_mfma_f32_16x16x32_bf16 v[88:91], v[140:143], v[152:155], v[88:91]
    v_mfma_f32_16x16x32_bf16 v[92:95], v[140:143], v[156:159], v[92:95]
    s_waitcnt lgkmcnt(0)
    v_mfma_f32_16x16x32_bf16 v[32:35], v[96:99], v[112:115], v[32:35]
    ds_read_b128 v[144:147], v17 offset:32768
    v_mfma_f32_16x16x32_bf16 v[36:39], v[96:99], v[116:119], v[36:39]
    ds_read_b64_tr_b16 v[128:129], v8 offset:57344
    v_mfma_f32_16x16x32_bf16 v[40:43], v[96:99], v[120:123], v[40:43]
    ds_read_b64_tr_b16 v[130:131], v8 offset:58368
    v_mfma_f32_16x16x32_bf16 v[44:47], v[96:99], v[124:127], v[44:47]
    ds_read_b128 v[148:151], v17 offset:34816
    v_mfma_f32_16x16x32_bf16 v[48:51], v[100:103], v[112:115], v[48:51]
    ds_read_b128 v[152:155], v17 offset:36864
    v_mfma_f32_16x16x32_bf16 v[52:55], v[100:103], v[116:119], v[52:55]
    ds_read_b128 v[156:159], v17 offset:38912
    v_mfma_f32_16x16x32_bf16 v[56:59], v[100:103], v[120:123], v[56:59]
    ds_read_b64_tr_b16 v[132:133], v9 offset:57344
    v_mfma_f32_16x16x32_bf16 v[60:63], v[100:103], v[124:127], v[60:63]
    ds_read_b64_tr_b16 v[134:135], v9 offset:58368
    v_mfma_f32_16x16x32_bf16 v[64:67], v[104:107], v[112:115], v[64:67]
    ds_read_b64_tr_b16 v[136:137], v10 offset:57344
    v_mfma_f32_16x16x32_bf16 v[68:71], v[104:107], v[116:119], v[68:71]
    ds_read_b64_tr_b16 v[138:139], v10 offset:58368
    v_mfma_f32_16x16x32_bf16 v[72:75], v[104:107], v[120:123], v[72:75]
    ds_read_b64_tr_b16 v[140:141], v11 offset:57344
    v_mfma_f32_16x16x32_bf16 v[76:79], v[104:107], v[124:127], v[76:79]
    ds_read_b64_tr_b16 v[142:143], v11 offset:58368
    v_mfma_f32_16x16x32_bf16 v[80:83], v[108:111], v[112:115], v[80:83]
    v_mfma_f32_16x16x32_bf16 v[84:87], v[108:111], v[116:119], v[84:87]
    v_mfma_f32_16x16x32_bf16 v[88:91], v[108:111], v[120:123], v[88:91]
    v_mfma_f32_16x16x32_bf16 v[92:95], v[108:111], v[124:127], v[92:95]
    s_waitcnt lgkmcnt(0)
    s_barrier
    v_mfma_f32_16x16x32_bf16 v[32:35], v[128:131], v[144:147], v[32:35]
    ds_read_b128 v[112:115], v18 offset:0
    v_mfma_f32_16x16x32_bf16 v[36:39], v[128:131], v[148:151], v[36:39]
    ds_read_b64_tr_b16 v[96:97], v12 offset:16384
    v_mfma_f32_16x16x32_bf16 v[40:43], v[128:131], v[152:155], v[40:43]
    ds_read_b64_tr_b16 v[98:99], v12 offset:17408
    v_mfma_f32_16x16x32_bf16 v[44:47], v[128:131], v[156:159], v[44:47]
    ds_read_b128 v[116:119], v18 offset:2048
    v_mfma_f32_16x16x32_bf16 v[48:51], v[132:135], v[144:147], v[48:51]
    ds_read_b128 v[120:123], v18 offset:4096
    v_mfma_f32_16x16x32_bf16 v[52:55], v[132:135], v[148:151], v[52:55]
    ds_read_b128 v[124:127], v18 offset:6144
    v_mfma_f32_16x16x32_bf16 v[56:59], v[132:135], v[152:155], v[56:59]
    ds_read_b64_tr_b16 v[100:101], v13 offset:16384
    v_mfma_f32_16x16x32_bf16 v[60:63], v[132:135], v[156:159], v[60:63]
    ds_read_b64_tr_b16 v[102:103], v13 offset:17408
    v_mfma_f32_16x16x32_bf16 v[64:67], v[136:139], v[144:147], v[64:67]
    ds_read_b64_tr_b16 v[104:105], v14 offset:16384
    v_mfma_f32_16x16x32_bf16 v[68:71], v[136:139], v[148:151], v[68:71]
    ds_read_b64_tr_b16 v[106:107], v14 offset:17408
    v_mfma_f32_16x16x32_bf16 v[72:75], v[136:139], v[152:155], v[72:75]
    ds_read_b64_tr_b16 v[108:109], v15 offset:16384
    v_mfma_f32_16x16x32_bf16 v[76:79], v[136:139], v[156:159], v[76:79]
    ds_read_b64_tr_b16 v[110:111], v15 offset:17408
    v_mfma_f32_16x16x32_bf16 v[80:83], v[140:143], v[144:147], v[80:83]
    v_mfma_f32_16x16x32_bf16 v[84:87], v[140:143], v[148:151], v[84:87]
    v_mfma_f32_16x16x32_bf16 v[88:91], v[140:143], v[152:155], v[88:91]
    v_mfma_f32_16x16x32_bf16 v[92:95], v[140:143], v[156:159], v[92:95]
    s_waitcnt lgkmcnt(0)
    v_mfma_f32_16x16x32_bf16 v[32:35], v[96:99], v[112:115], v[32:35]
    ds_read_b128 v[144:147], v19 offset:0
    v_mfma_f32_16x16x32_bf16 v[36:39], v[96:99], v[116:119], v[36:39]
    ds_read_b64_tr_b16 v[128:129], v12 offset:24576
    v_mfma_f32_16x16x32_bf16 v[40:43], v[96:99], v[120:123], v[40:43]
    ds_read_b64_tr_b16 v[130:131], v12 offset:25600
    v_mfma_f32_16x16x32_bf16 v[44:47], v[96:99], v[124:127], v[44:47]
    ds_read_b128 v[148:151], v19 offset:2048
    v_mfma_f32_16x16x32_bf16 v[48:51], v[100:103], v[112:115], v[48:51]
    ds_read_b128 v[152:155], v19 offset:4096
    v_mfma_f32_16x16x32_bf16 v[52:55], v[100:103], v[116:119], v[52:55]
    ds_read_b128 v[156:159], v19 offset:6144
    v_mfma_f32_16x16x32_bf16 v[56:59], v[100:103], v[120:123], v[56:59]
    ds_read_b64_tr_b16 v[132:133], v13 offset:24576
    v_mfma_f32_16x16x32_bf16 v[60:63], v[100:103], v[124:127], v[60:63]
    ds_read_b64_tr_b16 v[134:135], v13 offset:25600
    v_mfma_f32_16x16x32_bf16 v[64:67], v[104:107], v[112:115], v[64:67]
    ds_read_b64_tr_b16 v[136:137], v14 offset:24576
    v_mfma_f32_16x16x32_bf16 v[68:71], v[104:107], v[116:119], v[68:71]
    ds_read_b64_tr_b16 v[138:139], v14 offset:25600
    v_mfma_f32_16x16x32_bf16 v[72:75], v[104:107], v[120:123], v[72:75]
    ds_read_b64_tr_b16 v[140:141], v15 offset:24576
    v_mfma_f32_16x16x32_bf16 v[76:79], v[104:107], v[124:127], v[76:79]
    ds_read_b64_tr_b16 v[142:143], v15 offset:25600
    v_mfma_f32_16x16x32_bf16 v[80:83], v[108:111], v[112:115], v[80:83]
    v_mfma_f32_16x16x32_bf16 v[84:87], v[108:111], v[116:119], v[84:87]
    v_mfma_f32_16x16x32_bf16 v[88:91], v[108:111], v[120:123], v[88:91]
    v_mfma_f32_16x16x32_bf16 v[92:95], v[108:111], v[124:127], v[92:95]
    s_waitcnt lgkmcnt(0)
    s_barrier
    v_mfma_f32_16x16x32_bf16 v[32:35], v[128:131], v[144:147], v[32:35]
    ds_read_b128 v[112:115], v18 offset:32768
    v_mfma_f32_16x16x32_bf16 v[36:39], v[128:131], v[148:151], v[36:39]
    ds_read_b64_tr_b16 v[96:97], v12 offset:49152
    v_mfma_f32_16x16x32_bf16 v[40:43], v[128:131], v[152:155], v[40:43]
    ds_read_b64_tr_b16 v[98:99], v12 offset:50176
    v_mfma_f32_16x16x32_bf16 v[44:47], v[128:131], v[156:159], v[44:47]
    ds_read_b128 v[116:119], v18 offset:34816
    v_mfma_f32_16x16x32_bf16 v[48:51], v[132:135], v[144:147], v[48:51]
    ds_read_b128 v[120:123], v18 offset:36864
    v_mfma_f32_16x16x32_bf16 v[52:55], v[132:135], v[148:151], v[52:55]
    ds_read_b128 v[124:127], v18 offset:38912
    v_mfma_f32_16x16x32_bf16 v[56:59], v[132:135], v[152:155], v[56:59]
    ds_read_b64_tr_b16 v[100:101], v13 offset:49152
    v_mfma_f32_16x16x32_bf16 v[60:63], v[132:135], v[156:159], v[60:63]
    ds_read_b64_tr_b16 v[102:103], v13 offset:50176
    v_mfma_f32_16x16x32_bf16 v[64:67], v[136:139], v[144:147], v[64:67]
    ds_read_b64_tr_b16 v[104:105], v14 offset:49152
    v_mfma_f32_16x16x32_bf16 v[68:71], v[136:139], v[148:151], v[68:71]
    ds_read_b64_tr_b16 v[106:107], v14 offset:50176
    v_mfma_f32_16x16x32_bf16 v[72:75], v[136:139], v[152:155], v[72:75]
    ds_read_b64_tr_b16 v[108:109], v15 offset:49152
    v_mfma_f32_16x16x32_bf16 v[76:79], v[136:139], v[156:159], v[76:79]
    ds_read_b64_tr_b16 v[110:111], v15 offset:50176
    v_mfma_f32_16x16x32_bf16 v[80:83], v[140:143], v[144:147], v[80:83]
    v_mfma_f32_16x16x32_bf16 v[84:87], v[140:143], v[148:151], v[84:87]
    v_mfma_f32_16x16x32_bf16 v[88:91], v[140:143], v[152:155], v[88:91]
    v_mfma_f32_16x16x32_bf16 v[92:95], v[140:143], v[156:159], v[92:95]
    s_waitcnt lgkmcnt(0)
    buffer_load_dword v184, v28, s[56:59], 0 offen sc1
    buffer_load_dword v185, v29, s[60:63], 0 offen sc1
    v_mfma_f32_16x16x32_bf16 v[32:35], v[96:99], v[112:115], v[32:35]
    ds_read_b128 v[144:147], v19 offset:32768
    v_mfma_f32_16x16x32_bf16 v[36:39], v[96:99], v[116:119], v[36:39]
    ds_read_b64_tr_b16 v[128:129], v12 offset:57344
    v_mfma_f32_16x16x32_bf16 v[40:43], v[96:99], v[120:123], v[40:43]
    ds_read_b64_tr_b16 v[130:131], v12 offset:58368
    v_mfma_f32_16x16x32_bf16 v[44:47], v[96:99], v[124:127], v[44:47]
    ds_read_b128 v[148:151], v19 offset:34816
    v_mfma_f32_16x16x32_bf16 v[48:51], v[100:103], v[112:115], v[48:51]
    ds_read_b128 v[152:155], v19 offset:36864
    v_mfma_f32_16x16x32_bf16 v[52:55], v[100:103], v[116:119], v[52:55]
    ds_read_b128 v[156:159], v19 offset:38912
    v_mfma_f32_16x16x32_bf16 v[56:59], v[100:103], v[120:123], v[56:59]
    ds_read_b64_tr_b16 v[132:133], v13 offset:57344
    v_mfma_f32_16x16x32_bf16 v[60:63], v[100:103], v[124:127], v[60:63]
    ds_read_b64_tr_b16 v[134:135], v13 offset:58368
    v_mfma_f32_16x16x32_bf16 v[64:67], v[104:107], v[112:115], v[64:67]
    ds_read_b64_tr_b16 v[136:137], v14 offset:57344
    v_mfma_f32_16x16x32_bf16 v[68:71], v[104:107], v[116:119], v[68:71]
    ds_read_b64_tr_b16 v[138:139], v14 offset:58368
    v_mfma_f32_16x16x32_bf16 v[72:75], v[104:107], v[120:123], v[72:75]
    ds_read_b64_tr_b16 v[140:141], v15 offset:57344
    v_mfma_f32_16x16x32_bf16 v[76:79], v[104:107], v[124:127], v[76:79]
    ds_read_b64_tr_b16 v[142:143], v15 offset:58368
    v_mfma_f32_16x16x32_bf16 v[80:83], v[108:111], v[112:115], v[80:83]
    v_mfma_f32_16x16x32_bf16 v[84:87], v[108:111], v[116:119], v[84:87]
    v_mfma_f32_16x16x32_bf16 v[88:91], v[108:111], v[120:123], v[88:91]
    v_mfma_f32_16x16x32_bf16 v[92:95], v[108:111], v[124:127], v[92:95]
    s_waitcnt lgkmcnt(0)
    v_mfma_f32_16x16x32_bf16 v[32:35], v[128:131], v[144:147], v[32:35]
    v_mfma_f32_16x16x32_bf16 v[36:39], v[128:131], v[148:151], v[36:39]
    v_mfma_f32_16x16x32_bf16 v[40:43], v[128:131], v[152:155], v[40:43]
    v_mfma_f32_16x16x32_bf16 v[44:47], v[128:131], v[156:159], v[44:47]
    v_mfma_f32_16x16x32_bf16 v[48:51], v[132:135], v[144:147], v[48:51]
    v_mfma_f32_16x16x32_bf16 v[52:55], v[132:135], v[148:151], v[52:55]
    v_mfma_f32_16x16x32_bf16 v[56:59], v[132:135], v[152:155], v[56:59]
    v_mfma_f32_16x16x32_bf16 v[60:63], v[132:135], v[156:159], v[60:63]
    v_mfma_f32_16x16x32_bf16 v[64:67], v[136:139], v[144:147], v[64:67]
    v_mfma_f32_16x16x32_bf16 v[68:71], v[136:139], v[148:151], v[68:71]
    v_mfma_f32_16x16x32_bf16 v[72:75], v[136:139], v[152:155], v[72:75]
    v_mfma_f32_16x16x32_bf16 v[76:79], v[136:139], v[156:159], v[76:79]
    v_mfma_f32_16x16x32_bf16 v[80:83], v[140:143], v[144:147], v[80:83]
    v_mfma_f32_16x16x32_bf16 v[84:87], v[140:143], v[148:151], v[84:87]
    v_mfma_f32_16x16x32_bf16 v[88:91], v[140:143], v[152:155], v[88:91]
    v_mfma_f32_16x16x32_bf16 v[92:95], v[140:143], v[156:159], v[92:95]
    v_mov_b32 v31, 1
    s_mov_b64 exec, 1
    ds_add_u32 v30, v31 offset:12
    s_mov_b64 exec, -1
    s_nop 7
    v_max_f32 v32, 0, v32
    v_max_f32 v33, 0, v33
    v_max_f32 v34, 0, v34
    v_max_f32 v35, 0, v35
    v_max_f32 v48, 0, v48
    v_max_f32 v49, 0, v49
    v_max_f32 v50, 0, v50
    v_max_f32 v51, 0, v51
    v_pk_mul_f32 v[32:33], v[32:33], v[32:33]
    v_pk_mul_f32 v[34:35], v[34:35], v[34:35]
    v_pk_mul_f32 v[48:49], v[48:49], v[48:49]
    v_pk_mul_f32 v[50:51], v[50:51], v[50:51]
    v_cvt_pk_bf16_f32 v96, v32, v33
    v_cvt_pk_bf16_f32 v97, v34, v35
    v_cvt_pk_bf16_f32 v98, v48, v49
    v_cvt_pk_bf16_f32 v99, v50, v51
    buffer_store_dwordx4 v[96:99], v20, s[32:35], 0 offen offset:0 sc1
    v_max_f32 v36, 0, v36
    v_max_f32 v37, 0, v37
    v_max_f32 v38, 0, v38
    v_max_f32 v39, 0, v39
    v_max_f32 v52, 0, v52
    v_max_f32 v53, 0, v53
    v_max_f32 v54, 0, v54
    v_max_f32 v55, 0, v55
    v_pk_mul_f32 v[36:37], v[36:37], v[36:37]
    v_pk_mul_f32 v[38:39], v[38:39], v[38:39]
    v_pk_mul_f32 v[52:53], v[52:53], v[52:53]
    v_pk_mul_f32 v[54:55], v[54:55], v[54:55]
    v_cvt_pk_bf16_f32 v100, v36, v37
    v_cvt_pk_bf16_f32 v101, v38, v39
    v_cvt_pk_bf16_f32 v102, v52, v53
    v_cvt_pk_bf16_f32 v103, v54, v55
    buffer_store_dwordx4 v[100:103], v20, s[32:35], 0 offen offset:1024 sc1
    v_max_f32 v40, 0, v40
    v_max_f32 v41, 0, v41
    v_max_f32 v42, 0, v42
    v_max_f32 v43, 0, v43
    v_max_f32 v56, 0, v56
    v_max_f32 v57, 0, v57
    v_max_f32 v58, 0, v58
    v_max_f32 v59, 0, v59
    v_pk_mul_f32 v[40:41], v[40:41], v[40:41]
    v_pk_mul_f32 v[42:43], v[42:43], v[42:43]
    v_pk_mul_f32 v[56:57], v[56:57], v[56:57]
    v_pk_mul_f32 v[58:59], v[58:59], v[58:59]
    v_cvt_pk_bf16_f32 v104, v40, v41
    v_cvt_pk_bf16_f32 v105, v42, v43
    v_cvt_pk_bf16_f32 v106, v56, v57
    v_cvt_pk_bf16_f32 v107, v58, v59
    buffer_store_dwordx4 v[104:107], v20, s[32:35], 0 offen offset:2048 sc1
    v_max_f32 v44, 0, v44
    v_max_f32 v45, 0, v45
    v_max_f32 v46, 0, v46
    v_max_f32 v47, 0, v47
    v_max_f32 v60, 0, v60
    v_max_f32 v61, 0, v61
    v_max_f32 v62, 0, v62
    v_max_f32 v63, 0, v63
    v_pk_mul_f32 v[44:45], v[44:45], v[44:45]
    v_pk_mul_f32 v[46:47], v[46:47], v[46:47]
    v_pk_mul_f32 v[60:61], v[60:61], v[60:61]
    v_pk_mul_f32 v[62:63], v[62:63], v[62:63]
    v_cvt_pk_bf16_f32 v108, v44, v45
    v_cvt_pk_bf16_f32 v109, v46, v47
    v_cvt_pk_bf16_f32 v110, v60, v61
    v_cvt_pk_bf16_f32 v111, v62, v63
    buffer_store_dwordx4 v[108:111], v20, s[32:35], 0 offen offset:3072 sc1
    v_max_f32 v64, 0, v64
    v_max_f32 v65, 0, v65
    v_max_f32 v66, 0, v66
    v_max_f32 v67, 0, v67
    v_max_f32 v80, 0, v80
    v_max_f32 v81, 0, v81
    v_max_f32 v82, 0, v82
    v_max_f32 v83, 0, v83
    v_pk_mul_f32 v[64:65], v[64:65], v[64:65]
    v_pk_mul_f32 v[66:67], v[66:67], v[66:67]
    v_pk_mul_f32 v[80:81], v[80:81], v[80:81]
    v_pk_mul_f32 v[82:83], v[82:83], v[82:83]
    v_cvt_pk_bf16_f32 v112, v64, v65
    v_cvt_pk_bf16_f32 v113, v66, v67
    v_cvt_pk_bf16_f32 v114, v80, v81
    v_cvt_pk_bf16_f32 v115, v82, v83
    buffer_store_dwordx4 v[112:115], v21, s[32:35], 0 offen offset:0 sc1
    v_max_f32 v68, 0, v68
    v_max_f32 v69, 0, v69
    v_max_f32 v70, 0, v70
    v_max_f32 v71, 0, v71
    v_max_f32 v84, 0, v84
    v_max_f32 v85, 0, v85
    v_max_f32 v86, 0, v86
    v_max_f32 v87, 0, v87
    v_pk_mul_f32 v[68:69], v[68:69], v[68:69]
    v_pk_mul_f32 v[70:71], v[70:71], v[70:71]
    v_pk_mul_f32 v[84:85], v[84:85], v[84:85]
    v_pk_mul_f32 v[86:87], v[86:87], v[86:87]
    v_cvt_pk_bf16_f32 v116, v68, v69
    v_cvt_pk_bf16_f32 v117, v70, v71
    v_cvt_pk_bf16_f32 v118, v84, v85
    v_cvt_pk_bf16_f32 v119, v86, v87
    buffer_store_dwordx4 v[116:119], v21, s[32:35], 0 offen offset:1024 sc1
    v_max_f32 v72, 0, v72
    v_max_f32 v73, 0, v73
    v_max_f32 v74, 0, v74
    v_max_f32 v75, 0, v75
    v_max_f32 v88, 0, v88
    v_max_f32 v89, 0, v89
    v_max_f32 v90, 0, v90
    v_max_f32 v91, 0, v91
    v_pk_mul_f32 v[72:73], v[72:73], v[72:73]
    v_pk_mul_f32 v[74:75], v[74:75], v[74:75]
    v_pk_mul_f32 v[88:89], v[88:89], v[88:89]
    v_pk_mul_f32 v[90:91], v[90:91], v[90:91]
    v_cvt_pk_bf16_f32 v120, v72, v73
    v_cvt_pk_bf16_f32 v121, v74, v75
    v_cvt_pk_bf16_f32 v122, v88, v89
    v_cvt_pk_bf16_f32 v123, v90, v91
    buffer_store_dwordx4 v[120:123], v21, s[32:35], 0 offen offset:2048 sc1
    v_max_f32 v76, 0, v76
    v_max_f32 v77, 0, v77
    v_max_f32 v78, 0, v78
    v_max_f32 v79, 0, v79
    v_max_f32 v92, 0, v92
    v_max_f32 v93, 0, v93
    v_max_f32 v94, 0, v94
    v_max_f32 v95, 0, v95
    v_pk_mul_f32 v[76:77], v[76:77], v[76:77]
    v_pk_mul_f32 v[78:79], v[78:79], v[78:79]
    v_pk_mul_f32 v[92:93], v[92:93], v[92:93]
    v_pk_mul_f32 v[94:95], v[94:95], v[94:95]
    v_cvt_pk_bf16_f32 v124, v76, v77
    v_cvt_pk_bf16_f32 v125, v78, v79
    v_cvt_pk_bf16_f32 v126, v92, v93
    v_cvt_pk_bf16_f32 v127, v94, v95
    buffer_store_dwordx4 v[124:127], v21, s[32:35], 0 offen offset:3072 sc1
    s_waitcnt vmcnt(8)
    v_readfirstlane_b32 s54, v185
    s_nop 1
    v_cmp_eq_u32 vcc, s54, v184
    s_cmp_eq_u32 s54, 0
    s_nop 1
    s_cselect_b64 s[6:7], 0, vcc
    s_cmp_eq_u64 s[6:7], -1
    s_cbranch_scc1 L_kg_kernel_wp_ok
    s_mov_b32 s68, 0
L_kg_kernel_wp:
    buffer_load_dword v184, v28, s[56:59], 0 offen sc1
    buffer_load_dword v185, v29, s[60:63], 0 offen sc1
    s_waitcnt vmcnt(0)
    v_readfirstlane_b32 s54, v185
    s_nop 1
    v_cmp_eq_u32 vcc, s54, v184
    s_cmp_eq_u32 s54, 0
    s_nop 1
    s_cselect_b64 s[6:7], 0, vcc
    s_cmp_eq_u64 s[6:7], -1
    s_cbranch_scc1 L_kg_kernel_wp_ok
    s_add_u32 s68, s68, 1
    s_cmp_lt_u32 s68, 200000
    s_cbranch_scc1 L_kg_kernel_wp
L_kg_kernel_wp_ok:
    s_lshl_b32 s6, s5, 12
    s_add_u32 s7, s6, 33280
    v_add_u32 v12, s7, v4
    v_add_u32 v13, 49152, v12
    s_add_u32 s6, s6, 16896
    v_add_u32 v8, s6, v4
    s_sub_u32 s6, s5, 1
    s_and_b32 s6, s6, 3
    s_lshl_b32 s6, s6, 12
    s_add_u32 s6, s6, 16896
    v_add_u32 v9, s6, v4
    s_sub_u32 s6, s5, 2
    s_and_b32 s6, s6, 3
    s_lshl_b32 s6, s6, 12
    s_add_u32 s6, s6, 16896
    v_add_u32 v10, s6, v4
    s_sub_u32 s6, s5, 3
    s_and_b32 s6, s6, 3
    s_lshl_b32 s6, s6, 12
    s_add_u32 s6, s6, 16896
    v_add_u32 v11, s6, v4
    s_mov_b32 s51, 0
    s_mov_b32 s50, 0
    buffer_load_dwordx4 v[160:163], v22, s[40:43], s50 offen offset:0 sc1
    buffer_load_dwordx4 v[164:167], v22, s[40:43], s50 offen offset:1024 sc1
    buffer_load_dwordx4 v[168:171], v22, s[40:43], s50 offen offset:2048 sc1
    buffer_load_dwordx4 v[172:175], v22, s[40:43], s50 offen offset:3072 sc1
    s_mov_b32 s50, 4096
    buffer_load_dwordx4 v[176:179], v22, s[40:43], s50 offen offset:0 sc1
    buffer_load_dwordx4 v[180:183], v22, s[40:43], s50 offen offset:1024 sc1
    buffer_load_dwordx4 v[184:187], v22, s[40:43], s50 offen offset:2048 sc1
    buffer_load_dwordx4 v[188:191], v22, s[40:43], s50 offen offset:3072 sc1
    s_waitcnt vmcnt(8)
    v_mov_b32 v31, s54
    s_mov_b64 exec, 1
    buffer_store_dword v31, v29, s[56:59], s55 offen sc1
    s_mov_b64 exec, -1
    s_mov_b32 s68, 0
L_kg_kernel_p1da:
    ds_read_b32 v31, v30 offset:12
    s_waitcnt lgkmcnt(0)
    v_readfirstlane_b32 s69, v31
    s_cmp_ge_u32 s69, 4
    s_cbranch_scc1 L_kg_kernel_p1da_ok
    s_add_u32 s68, s68, 1
    s_cmp_lt_u32 s68, 3200000
    s_cbranch_scc1 L_kg_kernel_p1da
L_kg_kernel_p1da_ok:
    s_mov_b32 s68, 0
L_kg_kernel_ysta:
    ds_read_b32 v31, v30 offset:44
    s_waitcnt lgkmcnt(0)
    v_readfirstlane_b32 s69, v31
    s_cmp_ge_u32 s69, 4
    s_cbranch_scc1 L_kg_kernel_ysta_ok
    s_add_u32 s68, s68, 1
    s_cmp_lt_u32 s68, 3200000
    s_cbranch_scc1 L_kg_kernel_ysta
L_kg_kernel_ysta_ok:
    s_lshl_b32 s6, s5, 12
    s_add_u32 m0, s6, 33280
    s_mov_b32 s50, 24576
    buffer_load_dwordx4 v22, s[40:43], s50 offen offset:0 sc1 lds
    buffer_load_dwordx4 v22, s[40:43], s50 offen offset:1024 sc1 lds
    buffer_load_dwordx4 v22, s[40:43], s50 offen offset:2048 sc1 lds
    buffer_load_dwordx4 v22, s[40:43], s50 offen offset:3072 sc1 lds
    s_lshl_b32 s6, s5, 12
    s_add_u32 m0, s6, 49664
    s_mov_b32 s50, 28672
    buffer_load_dwordx4 v22, s[40:43], s50 offen offset:0 sc1 lds
    buffer_load_dwordx4 v22, s[40:43], s50 offen offset:1024 sc1 lds
    buffer_load_dwordx4 v22, s[40:43], s50 offen offset:2048 sc1 lds
    buffer_load_dwordx4 v22, s[40:43], s50 offen offset:3072 sc1 lds
    s_lshl_b32 s6, s5, 12
    s_add_u32 m0, s6, 66048
    s_mov_b32 s50, 32768
    buffer_load_dwordx4 v22, s[40:43], s50 offen offset:0 sc1 lds
    buffer_load_dwordx4 v22, s[40:43], s50 offen offset:1024 sc1 lds
    buffer_load_dwordx4 v22, s[40:43], s50 offen offset:2048 sc1 lds
    buffer_load_dwordx4 v22, s[40:43], s50 offen offset:3072 sc1 lds
    s_lshl_b32 s6, s5, 12
    s_add_u32 m0, s6, 82432
    s_mov_b32 s50, 36864
    buffer_load_dwordx4 v22, s[40:43], s50 offen offset:0 sc1 lds
    buffer_load_dwordx4 v22, s[40:43], s50 offen offset:1024 sc1 lds
    buffer_load_dwordx4 v22, s[40:43], s50 offen offset:2048 sc1 lds
    buffer_load_dwordx4 v22, s[40:43], s50 offen offset:3072 sc1 lds
    s_lshl_b32 s6, s5, 12
    s_add_u32 m0, s6, 98816
    s_mov_b32 s50, 40960
    buffer_load_dwordx4 v22, s[40:43], s50 offen offset:0 sc1 lds
    buffer_load_dwordx4 v22, s[40:43], s50 offen offset:1024 sc1 lds
    buffer_load_dwordx4 v22, s[40:43], s50 offen offset:2048 sc1 lds
    buffer_load_dwordx4 v22, s[40:43], s50 offen offset:3072 sc1 lds
    s_lshl_b32 s6, s5, 12
    s_add_u32 m0, s6, 115200
    s_mov_b32 s50, 45056
    buffer_load_dwordx4 v22, s[40:43], s50 offen offset:0 sc1 lds
    buffer_load_dwordx4 v22, s[40:43], s50 offen offset:1024 sc1 lds
    buffer_load_dwordx4 v22, s[40:43], s50 offen offset:2048 sc1 lds
    buffer_load_dwordx4 v22, s[40:43], s50 offen offset:3072 sc1 lds
    s_mov_b32 s50, 8192
    buffer_load_dwordx4 v[192:195], v22, s[40:43], s50 offen offset:0 sc1
    buffer_load_dwordx4 v[196:199], v22, s[40:43], s50 offen offset:1024 sc1
    buffer_load_dwordx4 v[200:203], v22, s[40:43], s50 offen offset:2048 sc1
    buffer_load_dwordx4 v[204:207], v22, s[40:43], s50 offen offset:3072 sc1
    s_mov_b32 s50, 12288
    buffer_load_dwordx4 v[208:211], v22, s[40:43], s50 offen offset:0 sc1
    buffer_load_dwordx4 v[212:215], v22, s[40:43], s50 offen offset:1024 sc1
    buffer_load_dwordx4 v[216:219], v22, s[40:43], s50 offen offset:2048 sc1
    buffer_load_dwordx4 v[220:223], v22, s[40:43], s50 offen offset:3072 sc1
    buffer_load_dword v31, v27, s[56:59], 0 offen sc1
    s_mov_b32 s50, 16384
    buffer_load_dwordx4 v[224:227], v22, s[40:43], s50 offen offset:0 sc1
    buffer_load_dwordx4 v[228:231], v22, s[40:43], s50 offen offset:1024 sc1
    buffer_load_dwordx4 v[232:235], v22, s[40:43], s50 offen offset:2048 sc1
    buffer_load_dwordx4 v[236:239], v22, s[40:43], s50 offen offset:3072 sc1
    s_mov_b32 s50, 20480
    buffer_load_dwordx4 v[240:243], v22, s[40:43], s50 offen offset:0 sc1
    buffer_load_dwordx4 v[244:247], v22, s[40:43], s50 offen offset:1024 sc1
    buffer_load_dwordx4 v[248:251], v22, s[40:43], s50 offen offset:2048 sc1
    buffer_load_dwordx4 v[252:255], v22, s[40:43], s50 offen offset:3072 sc1
    s_waitcnt vmcnt(8)
    v_cmp_eq_u32 vcc, s54, v31
    s_nop 1
    s_cmp_eq_u64 vcc, -1
    s_cbranch_scc1 L_kg_kernel_hfp_ok
L_kg_kernel_p2:
    s_mov_b32 s68, 0
L_kg_kernel_hfp:
    buffer_load_dword v31, v27, s[56:59], 0 offen sc1
    s_waitcnt vmcnt(0)
    v_cmp_eq_u32 vcc, s54, v31
    s_nop 1
    s_cmp_eq_u64 vcc, -1
    s_cbranch_scc1 L_kg_kernel_hfp_ok
    s_add_u32 s68, s68, 1
    s_cmp_lt_u32 s68, 200000
    s_cbranch_scc1 L_kg_kernel_hfp
L_kg_kernel_hfp_ok:
    buffer_load_dwordx4 v[96:99], v23, s[32:35], s51 offen sc1
    buffer_load_dwordx4 v[100:103], v24, s[32:35], s51 offen sc1
    buffer_load_dwordx4 v[104:107], v25, s[32:35], s51 offen sc1
    buffer_load_dwordx4 v[108:111], v26, s[32:35], s51 offen sc1
    s_add_u32 s51, s51, 4096
    buffer_load_dwordx4 v[112:115], v23, s[32:35], s51 offen sc1
    buffer_load_dwordx4 v[116:119], v24, s[32:35], s51 offen sc1
    buffer_load_dwordx4 v[120:123], v25, s[32:35], s51 offen sc1
    buffer_load_dwordx4 v[124:127], v26, s[32:35], s51 offen sc1
    s_add_u32 s51, s51, 4096
    buffer_load_dwordx4 v[128:131], v23, s[32:35], s51 offen sc1
    buffer_load_dwordx4 v[132:135], v24, s[32:35], s51 offen sc1
    buffer_load_dwordx4 v[136:139], v25, s[32:35], s51 offen sc1
    buffer_load_dwordx4 v[140:143], v26, s[32:35], s51 offen sc1
    s_add_u32 s51, s51, 4096
    buffer_load_dwordx4 v[144:147], v23, s[32:35], s51 offen sc1
    buffer_load_dwordx4 v[148:151], v24, s[32:35], s51 offen sc1
    buffer_load_dwordx4 v[152:155], v25, s[32:35], s51 offen sc1
    buffer_load_dwordx4 v[156:159], v26, s[32:35], s51 offen sc1
    s_add_u32 s51, s51, 4096
    s_mov_b32 s50, 49152
    s_waitcnt vmcnt(12)
    v_mfma_f32_16x16x32_bf16 v[32:35], v[160:163], v[96:99], 0
    v_mfma_f32_16x16x32_bf16 v[36:39], v[164:167], v[96:99], 0
    v_mfma_f32_16x16x32_bf16 v[40:43], v[168:171], v[96:99], 0
    v_mfma_f32_16x16x32_bf16 v[44:47], v[172:175], v[96:99], 0
    buffer_load_dwordx4 v[96:99], v23, s[32:35], s51 offen sc1
    v_mfma_f32_16x16x32_bf16 v[48:51], v[160:163], v[100:103], 0
    v_mfma_f32_16x16x32_bf16 v[64:67], v[160:163], v[104:107], 0
    v_mfma_f32_16x16x32_bf16 v[80:83], v[160:163], v[108:111], 0
    ds_read_b128 v[160:163], v12 offset:0
    v_mfma_f32_16x16x32_bf16 v[52:55], v[164:167], v[100:103], 0
    v_mfma_f32_16x16x32_bf16 v[56:59], v[168:171], v[100:103], 0
    v_mfma_f32_16x16x32_bf16 v[60:63], v[172:175], v[100:103], 0
    buffer_load_dwordx4 v[100:103], v24, s[32:35], s51 offen sc1
    v_mfma_f32_16x16x32_bf16 v[68:71], v[164:167], v[104:107], 0
    v_mfma_f32_16x16x32_bf16 v[84:87], v[164:167], v[108:111], 0
    ds_read_b128 v[164:167], v12 offset:1024
    v_mfma_f32_16x16x32_bf16 v[72:75], v[168:171], v[104:107], 0
    v_mfma_f32_16x16x32_bf16 v[76:79], v[172:175], v[104:107], 0
    buffer_load_dwordx4 v[104:107], v25, s[32:35], s51 offen sc1
    v_mfma_f32_16x16x32_bf16 v[88:91], v[168:171], v[108:111], 0
    ds_read_b128 v[168:171], v12 offset:2048
    v_mfma_f32_16x16x32_bf16 v[92:95], v[172:175], v[108:111], 0
    buffer_load_dwordx4 v[108:111], v26, s[32:35], s51 offen sc1
    ds_read_b128 v[172:175], v12 offset:3072
    s_add_u32 s51, s51, 4096
    s_waitcnt vmcnt(12)
    v_mfma_f32_16x16x32_bf16 v[32:35], v[176:179], v[112:115], v[32:35]
    v_mfma_f32_16x16x32_bf16 v[36:39], v[180:183], v[112:115], v[36:39]
    v_mfma_f32_16x16x32_bf16 v[40:43], v[184:187], v[112:115], v[40:43]
    v_mfma_f32_16x16x32_bf16 v[44:47], v[188:191], v[112:115], v[44:47]
    buffer_load_dwordx4 v[112:115], v23, s[32:35], s51 offen sc1
    v_mfma_f32_16x16x32_bf16 v[48:51], v[176:179], v[116:119], v[48:51]
    v_mfma_f32_16x16x32_bf16 v[64:67], v[176:179], v[120:123], v[64:67]
    v_mfma_f32_16x16x32_bf16 v[80:83], v[176:179], v[124:127], v[80:83]
    ds_read_b128 v[176:179], v12 offset:16384
    v_mfma_f32_16x16x32_bf16 v[52:55], v[180:183], v[116:119], v[52:55]
    v_mfma_f32_16x16x32_bf16 v[56:59], v[184:187], v[116:119], v[56:59]
    v_mfma_f32_16x16x32_bf16 v[60:63], v[188:191], v[116:119], v[60:63]
    buffer_load_dwordx4 v[116:119], v24, s[32:35], s51 offen sc1
    v_mfma_f32_16x16x32_bf16 v[68:71], v[180:183], v[120:123], v[68:71]
    v_mfma_f32_16x16x32_bf16 v[84:87], v[180:183], v[124:127], v[84:87]
    ds_read_b128 v[180:183], v12 offset:17408
    v_mfma_f32_16x16x32_bf16 v[72:75], v[184:187], v[120:123], v[72:75]
    v_mfma_f32_16x16x32_bf16 v[76:79], v[188:191], v[120:123], v[76:79]
    buffer_load_dwordx4 v[120:123], v25, s[32:35], s51 offen sc1
    v_mfma_f32_16x16x32_bf16 v[88:91], v[184:187], v[124:127], v[88:91]
    ds_read_b128 v[184:187], v12 offset:18432
    v_mfma_f32_16x16x32_bf16 v[92:95], v[188:191], v[124:127], v[92:95]
    buffer_load_dwordx4 v[124:127], v26, s[32:35], s51 offen sc1
    ds_read_b128 v[188:191], v12 offset:19456
    s_add_u32 s51, s51, 4096
    s_waitcnt vmcnt(12)
    v_mfma_f32_16x16x32_bf16 v[32:35], v[192:195], v[128:131], v[32:35]
    v_mfma_f32_16x16x32_bf16 v[36:39], v[196:199], v[128:131], v[36:39]
    v_mfma_f32_16x16x32_bf16 v[40:43], v[200:203], v[128:131], v[40:43]
    v_mfma_f32_16x16x32_bf16 v[44:47], v[204:207], v[128:131], v[44:47]
    buffer_load_dwordx4 v[128:131], v23, s[32:35], s51 offen sc1
    v_mfma_f32_16x16x32_bf16 v[48:51], v[192:195], v[132:135], v[48:51]
    v_mfma_f32_16x16x32_bf16 v[64:67], v[192:195], v[136:139], v[64:67]
    v_mfma_f32_16x16x32_bf16 v[80:83], v[192:195], v[140:143], v[80:83]
    ds_read_b128 v[192:195], v12 offset:32768
    v_mfma_f32_16x16x32_bf16 v[52:55], v[196:199], v[132:135], v[52:55]
    v_mfma_f32_16x16x32_bf16 v[56:59], v[200:203], v[132:135], v[56:59]
    v_mfma_f32_16x16x32_bf16 v[60:63], v[204:207], v[132:135], v[60:63]
    buffer_load_dwordx4 v[132:135], v24, s[32:35], s51 offen sc1
    v_mfma_f32_16x16x32_bf16 v[68:71], v[196:199], v[136:139], v[68:71]
    v_mfma_f32_16x16x32_bf16 v[84:87], v[196:199], v[140:143], v[84:87]
    ds_read_b128 v[196:199], v12 offset:33792
    v_mfma_f32_16x16x32_bf16 v[72:75], v[200:203], v[136:139], v[72:75]
    v_mfma_f32_16x16x32_bf16 v[76:79], v[204:207], v[136:139], v[76:79]
    buffer_load_dwordx4 v[136:139], v25, s[32:35], s51 offen sc1
    v_mfma_f32_16x16x32_bf16 v[88:91], v[200:203], v[140:143], v[88:91]
    ds_read_b128 v[200:203], v12 offset:34816
    v_mfma_f32_16x16x32_bf16 v[92:95], v[204:207], v[140:143], v[92:95]
    buffer_load_dwordx4 v[140:143], v26, s[32:35], s51 offen sc1
    ds_read_b128 v[204:207], v12 offset:35840
    s_add_u32 s51, s51, 4096
    s_waitcnt vmcnt(12)
    v_mfma_f32_16x16x32_bf16 v[32:35], v[208:211], v[144:147], v[32:35]
    v_mfma_f32_16x16x32_bf16 v[36:39], v[212:215], v[144:147], v[36:39]
    v_mfma_f32_16x16x32_bf16 v[40:43], v[216:219], v[144:147], v[40:43]
    v_mfma_f32_16x16x32_bf16 v[44:47], v[220:223], v[144:147], v[44:47]
    buffer_load_dwordx4 v[144:147], v23, s[32:35], s51 offen sc1
    v_mfma_f32_16x16x32_bf16 v[48:51], v[208:211], v[148:151], v[48:51]
    v_mfma_f32_16x16x32_bf16 v[64:67], v[208:211], v[152:155], v[64:67]
    v_mfma_f32_16x16x32_bf16 v[80:83], v[208:211], v[156:159], v[80:83]
    ds_read_b128 v[208:211], v13 offset:0
    v_mfma_f32_16x16x32_bf16 v[52:55], v[212:215], v[148:151], v[52:55]
    v_mfma_f32_16x16x32_bf16 v[56:59], v[216:219], v[148:151], v[56:59]
    v_mfma_f32_16x16x32_bf16 v[60:63], v[220:223], v[148:151], v[60:63]
    buffer_load_dwordx4 v[148:151], v24, s[32:35], s51 offen sc1
    v_mfma_f32_16x16x32_bf16 v[68:71], v[212:215], v[152:155], v[68:71]
    v_mfma_f32_16x16x32_bf16 v[84:87], v[212:215], v[156:159], v[84:87]
    ds_read_b128 v[212:215], v13 offset:1024
    v_mfma_f32_16x16x32_bf16 v[72:75], v[216:219], v[152:155], v[72:75]
    v_mfma_f32_16x16x32_bf16 v[76:79], v[220:223], v[152:155], v[76:79]
    buffer_load_dwordx4 v[152:155], v25, s[32:35], s51 offen sc1
    v_mfma_f32_16x16x32_bf16 v[88:91], v[216:219], v[156:159], v[88:91]
    ds_read_b128 v[216:219], v13 offset:2048
    v_mfma_f32_16x16x32_bf16 v[92:95], v[220:223], v[156:159], v[92:95]
    buffer_load_dwordx4 v[156:159], v26, s[32:35], s51 offen sc1
    ds_read_b128 v[220:223], v13 offset:3072
    s_add_u32 s51, s51, 4096
    s_waitcnt vmcnt(12)
    v_mfma_f32_16x16x32_bf16 v[32:35], v[224:227], v[96:99], v[32:35]
    v_mfma_f32_16x16x32_bf16 v[36:39], v[228:231], v[96:99], v[36:39]
    v_mfma_f32_16x16x32_bf16 v[40:43], v[232:235], v[96:99], v[40:43]
    v_mfma_f32_16x16x32_bf16 v[44:47], v[236:239], v[96:99], v[44:47]
    buffer_load_dwordx4 v[96:99], v23, s[32:35], s51 offen sc1
    v_mfma_f32_16x16x32_bf16 v[48:51], v[224:227], v[100:103], v[48:51]
    v_mfma_f32_16x16x32_bf16 v[64:67], v[224:227], v[104:107], v[64:67]
    v_mfma_f32_16x16x32_bf16 v[80:83], v[224:227], v[108:111], v[80:83]
    ds_read_b128 v[224:227], v13 offset:16384
    v_mfma_f32_16x16x32_bf16 v[52:55], v[228:231], v[100:103], v[52:55]
    v_mfma_f32_16x16x32_bf16 v[56:59], v[232:235], v[100:103], v[56:59]
    v_mfma_f32_16x16x32_bf16 v[60:63], v[236:239], v[100:103], v[60:63]
    buffer_load_dwordx4 v[100:103], v24, s[32:35], s51 offen sc1
    v_mfma_f32_16x16x32_bf16 v[68:71], v[228:231], v[104:107], v[68:71]
    v_mfma_f32_16x16x32_bf16 v[84:87], v[228:231], v[108:111], v[84:87]
    ds_read_b128 v[228:231], v13 offset:17408
    v_mfma_f32_16x16x32_bf16 v[72:75], v[232:235], v[104:107], v[72:75]
    v_mfma_f32_16x16x32_bf16 v[76:79], v[236:239], v[104:107], v[76:79]
    buffer_load_dwordx4 v[104:107], v25, s[32:35], s51 offen sc1
    v_mfma_f32_16x16x32_bf16 v[88:91], v[232:235], v[108:111], v[88:91]
    ds_read_b128 v[232:235], v13 offset:18432
    v_mfma_f32_16x16x32_bf16 v[92:95], v[236:239], v[108:111], v[92:95]
    buffer_load_dwordx4 v[108:111], v26, s[32:35], s51 offen sc1
    ds_read_b128 v[236:239], v13 offset:19456
    s_add_u32 s51, s51, 4096
    s_waitcnt vmcnt(12)
    v_mfma_f32_16x16x32_bf16 v[32:35], v[240:243], v[112:115], v[32:35]
    v_mfma_f32_16x16x32_bf16 v[36:39], v[244:247], v[112:115], v[36:39]
    v_mfma_f32_16x16x32_bf16 v[40:43], v[248:251], v[112:115], v[40:43]
    v_mfma_f32_16x16x32_bf16 v[44:47], v[252:255], v[112:115], v[44:47]
    buffer_load_dwordx4 v[112:115], v23, s[32:35], s51 offen sc1
    v_mfma_f32_16x16x32_bf16 v[48:51], v[240:243], v[116:119], v[48:51]
    v_mfma_f32_16x16x32_bf16 v[64:67], v[240:243], v[120:123], v[64:67]
    v_mfma_f32_16x16x32_bf16 v[80:83], v[240:243], v[124:127], v[80:83]
    ds_read_b128 v[240:243], v13 offset:32768
    v_mfma_f32_16x16x32_bf16 v[52:55], v[244:247], v[116:119], v[52:55]
    v_mfma_f32_16x16x32_bf16 v[56:59], v[248:251], v[116:119], v[56:59]
    v_mfma_f32_16x16x32_bf16 v[60:63], v[252:255], v[116:119], v[60:63]
    buffer_load_dwordx4 v[116:119], v24, s[32:35], s51 offen sc1
    v_mfma_f32_16x16x32_bf16 v[68:71], v[244:247], v[120:123], v[68:71]
    v_mfma_f32_16x16x32_bf16 v[84:87], v[244:247], v[124:127], v[84:87]
    ds_read_b128 v[244:247], v13 offset:33792
    v_mfma_f32_16x16x32_bf16 v[72:75], v[248:251], v[120:123], v[72:75]
    v_mfma_f32_16x16x32_bf16 v[76:79], v[252:255], v[120:123], v[76:79]
    buffer_load_dwordx4 v[120:123], v25, s[32:35], s51 offen sc1
    v_mfma_f32_16x16x32_bf16 v[88:91], v[248:251], v[124:127], v[88:91]
    ds_read_b128 v[248:251], v13 offset:34816
    v_mfma_f32_16x16x32_bf16 v[92:95], v[252:255], v[124:127], v[92:95]
    buffer_load_dwordx4 v[124:127], v26, s[32:35], s51 offen sc1
    ds_read_b128 v[252:255], v13 offset:35840
    s_add_u32 s51, s51, 4096
    s_waitcnt vmcnt(12)
    s_waitcnt lgkmcnt(0)
    v_mfma_f32_16x16x32_bf16 v[32:35], v[160:163], v[128:131], v[32:35]
    v_mfma_f32_16x16x32_bf16 v[36:39], v[164:167], v[128:131], v[36:39]
    v_mfma_f32_16x16x32_bf16 v[40:43], v[168:171], v[128:131], v[40:43]
    v_mfma_f32_16x16x32_bf16 v[44:47], v[172:175], v[128:131], v[44:47]
    buffer_load_dwordx4 v[128:131], v23, s[32:35], s51 offen sc1
    v_mfma_f32_16x16x32_bf16 v[48:51], v[160:163], v[132:135], v[48:51]
    v_mfma_f32_16x16x32_bf16 v[64:67], v[160:163], v[136:139], v[64:67]
    v_mfma_f32_16x16x32_bf16 v[80:83], v[160:163], v[140:143], v[80:83]
    buffer_load_dwordx4 v[160:163], v22, s[40:43], s50 offen offset:0 sc1
    v_mfma_f32_16x16x32_bf16 v[52:55], v[164:167], v[132:135], v[52:55]
    v_mfma_f32_16x16x32_bf16 v[56:59], v[168:171], v[132:135], v[56:59]
    v_mfma_f32_16x16x32_bf16 v[60:63], v[172:175], v[132:135], v[60:63]
    buffer_load_dwordx4 v[132:135], v24, s[32:35], s51 offen sc1
    v_mfma_f32_16x16x32_bf16 v[68:71], v[164:167], v[136:139], v[68:71]
    v_mfma_f32_16x16x32_bf16 v[84:87], v[164:167], v[140:143], v[84:87]
    buffer_load_dwordx4 v[164:167], v22, s[40:43], s50 offen offset:1024 sc1
    v_mfma_f32_16x16x32_bf16 v[72:75], v[168:171], v[136:139], v[72:75]
    v_mfma_f32_16x16x32_bf16 v[76:79], v[172:175], v[136:139], v[76:79]
    buffer_load_dwordx4 v[136:139], v25, s[32:35], s51 offen sc1
    v_mfma_f32_16x16x32_bf16 v[88:91], v[168:171], v[140:143], v[88:91]
    buffer_load_dwordx4 v[168:171], v22, s[40:43], s50 offen offset:2048 sc1
    v_mfma_f32_16x16x32_bf16 v[92:95], v[172:175], v[140:143], v[92:95]
    buffer_load_dwordx4 v[140:143], v26, s[32:35], s51 offen sc1
    buffer_load_dwordx4 v[172:175], v22, s[40:43], s50 offen offset:3072 sc1
    s_add_u32 s50, s50, 4096
    s_add_u32 s51, s51, 4096
    s_waitcnt vmcnt(16)
    s_waitcnt lgkmcnt(0)
    v_mfma_f32_16x16x32_bf16 v[32:35], v[176:179], v[144:147], v[32:35]
    v_mfma_f32_16x16x32_bf16 v[36:39], v[180:183], v[144:147], v[36:39]
    v_mfma_f32_16x16x32_bf16 v[40:43], v[184:187], v[144:147], v[40:43]
    v_mfma_f32_16x16x32_bf16 v[44:47], v[188:191], v[144:147], v[44:47]
    buffer_load_dwordx4 v[144:147], v23, s[32:35], s51 offen sc1
    v_mfma_f32_16x16x32_bf16 v[48:51], v[176:179], v[148:151], v[48:51]
    v_mfma_f32_16x16x32_bf16 v[64:67], v[176:179], v[152:155], v[64:67]
    v_mfma_f32_16x16x32_bf16 v[80:83], v[176:179], v[156:159], v[80:83]
    buffer_load_dwordx4 v[176:179], v22, s[40:43], s50 offen offset:0 sc1
    v_mfma_f32_16x16x32_bf16 v[52:55], v[180:183], v[148:151], v[52:55]
    v_mfma_f32_16x16x32_bf16 v[56:59], v[184:187], v[148:151], v[56:59]
    v_mfma_f32_16x16x32_bf16 v[60:63], v[188:191], v[148:151], v[60:63]
    buffer_load_dwordx4 v[148:151], v24, s[32:35], s51 offen sc1
    v_mfma_f32_16x16x32_bf16 v[68:71], v[180:183], v[152:155], v[68:71]
    v_mfma_f32_16x16x32_bf16 v[84:87], v[180:183], v[156:159], v[84:87]
    buffer_load_dwordx4 v[180:183], v22, s[40:43], s50 offen offset:1024 sc1
    v_mfma_f32_16x16x32_bf16 v[72:75], v[184:187], v[152:155], v[72:75]
    v_mfma_f32_16x16x32_bf16 v[76:79], v[188:191], v[152:155], v[76:79]
    buffer_load_dwordx4 v[152:155], v25, s[32:35], s51 offen sc1
    v_mfma_f32_16x16x32_bf16 v[88:91], v[184:187], v[156:159], v[88:91]
    buffer_load_dwordx4 v[184:187], v22, s[40:43], s50 offen offset:2048 sc1
    v_mfma_f32_16x16x32_bf16 v[92:95], v[188:191], v[156:159], v[92:95]
    buffer_load_dwordx4 v[156:159], v26, s[32:35], s51 offen sc1
    buffer_load_dwordx4 v[188:191], v22, s[40:43], s50 offen offset:3072 sc1
    s_add_u32 s50, s50, 4096
    s_add_u32 s51, s51, 4096
    s_waitcnt vmcnt(20)
    s_waitcnt lgkmcnt(0)
    v_mfma_f32_16x16x32_bf16 v[32:35], v[192:195], v[96:99], v[32:35]
    v_mfma_f32_16x16x32_bf16 v[36:39], v[196:199], v[96:99], v[36:39]
    v_mfma_f32_16x16x32_bf16 v[40:43], v[200:203], v[96:99], v[40:43]
    v_mfma_f32_16x16x32_bf16 v[44:47], v[204:207], v[96:99], v[44:47]
    buffer_load_dwordx4 v[96:99], v23, s[32:35], s51 offen sc1
    v_mfma_f32_16x16x32_bf16 v[48:51], v[192:195], v[100:103], v[48:51]
    v_mfma_f32_16x16x32_bf16 v[64:67], v[192:195], v[104:107], v[64:67]
    v_mfma_f32_16x16x32_bf16 v[80:83], v[192:195], v[108:111], v[80:83]
    v_mfma_f32_16x16x32_bf16 v[52:55], v[196:199], v[100:103], v[52:55]
    v_mfma_f32_16x16x32_bf16 v[56:59], v[200:203], v[100:103], v[56:59]
    v_mfma_f32_16x16x32_bf16 v[60:63], v[204:207], v[100:103], v[60:63]
    buffer_load_dwordx4 v[100:103], v24, s[32:35], s51 offen sc1
    v_mfma_f32_16x16x32_bf16 v[68:71], v[196:199], v[104:107], v[68:71]
    v_mfma_f32_16x16x32_bf16 v[84:87], v[196:199], v[108:111], v[84:87]
    v_mfma_f32_16x16x32_bf16 v[72:75], v[200:203], v[104:107], v[72:75]
    v_mfma_f32_16x16x32_bf16 v[76:79], v[204:207], v[104:107], v[76:79]
    buffer_load_dwordx4 v[104:107], v25, s[32:35], s51 offen sc1
    v_mfma_f32_16x16x32_bf16 v[88:91], v[200:203], v[108:111], v[88:91]
    v_mfma_f32_16x16x32_bf16 v[92:95], v[204:207], v[108:111], v[92:95]
    buffer_load_dwordx4 v[108:111], v26, s[32:35], s51 offen sc1
    s_add_u32 s51, s51, 4096
    s_waitcnt vmcnt(20)
    s_waitcnt lgkmcnt(0)
    v_mfma_f32_16x16x32_bf16 v[32:35], v[208:211], v[112:115], v[32:35]
    v_mfma_f32_16x16x32_bf16 v[36:39], v[212:215], v[112:115], v[36:39]
    v_mfma_f32_16x16x32_bf16 v[40:43], v[216:219], v[112:115], v[40:43]
    v_mfma_f32_16x16x32_bf16 v[44:47], v[220:223], v[112:115], v[44:47]
    buffer_load_dwordx4 v[112:115], v23, s[32:35], s51 offen sc1
    v_mfma_f32_16x16x32_bf16 v[48:51], v[208:211], v[116:119], v[48:51]
    v_mfma_f32_16x16x32_bf16 v[64:67], v[208:211], v[120:123], v[64:67]
    v_mfma_f32_16x16x32_bf16 v[80:83], v[208:211], v[124:127], v[80:83]
    v_mfma_f32_16x16x32_bf16 v[52:55], v[212:215], v[116:119], v[52:55]
    v_mfma_f32_16x16x32_bf16 v[56:59], v[216:219], v[116:119], v[56:59]
    v_mfma_f32_16x16x32_bf16 v[60:63], v[220:223], v[116:119], v[60:63]
    buffer_load_dwordx4 v[116:119], v24, s[32:35], s51 offen sc1
    v_mfma_f32_16x16x32_bf16 v[68:71], v[212:215], v[120:123], v[68:71]
    v_mfma_f32_16x16x32_bf16 v[84:87], v[212:215], v[124:127], v[84:87]
    v_mfma_f32_16x16x32_bf16 v[72:75], v[216:219], v[120:123], v[72:75]
    v_mfma_f32_16x16x32_bf16 v[76:79], v[220:223], v[120:123], v[76:79]
    buffer_load_dwordx4 v[120:123], v25, s[32:35], s51 offen sc1
    v_mfma_f32_16x16x32_bf16 v[88:91], v[216:219], v[124:127], v[88:91]
    v_mfma_f32_16x16x32_bf16 v[92:95], v[220:223], v[124:127], v[92:95]
    buffer_load_dwordx4 v[124:127], v26, s[32:35], s51 offen sc1
    s_add_u32 s51, s51, 4096
    s_waitcnt vmcnt(17)
    s_waitcnt lgkmcnt(0)
    v_mfma_f32_16x16x32_bf16 v[32:35], v[224:227], v[128:131], v[32:35]
    v_mfma_f32_16x16x32_bf16 v[36:39], v[228:231], v[128:131], v[36:39]
    v_mfma_f32_16x16x32_bf16 v[40:43], v[232:235], v[128:131], v[40:43]
    v_mfma_f32_16x16x32_bf16 v[44:47], v[236:239], v[128:131], v[44:47]
    v_mfma_f32_16x16x32_bf16 v[48:51], v[224:227], v[132:135], v[48:51]
    v_mfma_f32_16x16x32_bf16 v[64:67], v[224:227], v[136:139], v[64:67]
    v_mfma_f32_16x16x32_bf16 v[80:83], v[224:227], v[140:143], v[80:83]
    v_mfma_f32_16x16x32_bf16 v[52:55], v[228:231], v[132:135], v[52:55]
    v_mfma_f32_16x16x32_bf16 v[56:59], v[232:235], v[132:135], v[56:59]
    v_mfma_f32_16x16x32_bf16 v[60:63], v[236:239], v[132:135], v[60:63]
    v_mfma_f32_16x16x32_bf16 v[68:71], v[228:231], v[136:139], v[68:71]
    v_mfma_f32_16x16x32_bf16 v[84:87], v[228:231], v[140:143], v[84:87]
    v_mfma_f32_16x16x32_bf16 v[72:75], v[232:235], v[136:139], v[72:75]
    v_mfma_f32_16x16x32_bf16 v[76:79], v[236:239], v[136:139], v[76:79]
    v_mfma_f32_16x16x32_bf16 v[88:91], v[232:235], v[140:143], v[88:91]
    v_mfma_f32_16x16x32_bf16 v[92:95], v[236:239], v[140:143], v[92:95]
    s_waitcnt vmcnt(9)
    s_waitcnt lgkmcnt(0)
    v_mfma_f32_16x16x32_bf16 v[32:35], v[240:243], v[144:147], v[32:35]
    v_mfma_f32_16x16x32_bf16 v[36:39], v[244:247], v[144:147], v[36:39]
    v_mfma_f32_16x16x32_bf16 v[40:43], v[248:251], v[144:147], v[40:43]
    v_mfma_f32_16x16x32_bf16 v[44:47], v[252:255], v[144:147], v[44:47]
    v_mfma_f32_16x16x32_bf16 v[48:51], v[240:243], v[148:151], v[48:51]
    v_mfma_f32_16x16x32_bf16 v[64:67], v[240:243], v[152:155], v[64:67]
    v_mfma_f32_16x16x32_bf16 v[80:83], v[240:243], v[156:159], v[80:83]
    v_mfma_f32_16x16x32_bf16 v[52:55], v[244:247], v[148:151], v[52:55]
    v_mfma_f32_16x16x32_bf16 v[56:59], v[248:251], v[148:151], v[56:59]
    v_mfma_f32_16x16x32_bf16 v[60:63], v[252:255], v[148:151], v[60:63]
    v_mfma_f32_16x16x32_bf16 v[68:71], v[244:247], v[152:155], v[68:71]
    v_mfma_f32_16x16x32_bf16 v[84:87], v[244:247], v[156:159], v[84:87]
    v_mfma_f32_16x16x32_bf16 v[72:75], v[248:251], v[152:155], v[72:75]
    v_mfma_f32_16x16x32_bf16 v[76:79], v[252:255], v[152:155], v[76:79]
    v_mfma_f32_16x16x32_bf16 v[88:91], v[248:251], v[156:159], v[88:91]
    v_mfma_f32_16x16x32_bf16 v[92:95], v[252:255], v[156:159], v[92:95]
    s_waitcnt vmcnt(4)
    v_mfma_f32_16x16x32_bf16 v[32:35], v[160:163], v[96:99], v[32:35]
    v_mfma_f32_16x16x32_bf16 v[36:39], v[164:167], v[96:99], v[36:39]
    v_mfma_f32_16x16x32_bf16 v[40:43], v[168:171], v[96:99], v[40:43]
    v_mfma_f32_16x16x32_bf16 v[44:47], v[172:175], v[96:99], v[44:47]
    v_mfma_f32_16x16x32_bf16 v[48:51], v[160:163], v[100:103], v[48:51]
    v_mfma_f32_16x16x32_bf16 v[64:67], v[160:163], v[104:107], v[64:67]
    v_mfma_f32_16x16x32_bf16 v[80:83], v[160:163], v[108:111], v[80:83]
    v_mfma_f32_16x16x32_bf16 v[52:55], v[164:167], v[100:103], v[52:55]
    v_mfma_f32_16x16x32_bf16 v[56:59], v[168:171], v[100:103], v[56:59]
    v_mfma_f32_16x16x32_bf16 v[60:63], v[172:175], v[100:103], v[60:63]
    v_mfma_f32_16x16x32_bf16 v[68:71], v[164:167], v[104:107], v[68:71]
    v_mfma_f32_16x16x32_bf16 v[84:87], v[164:167], v[108:111], v[84:87]
    v_mfma_f32_16x16x32_bf16 v[72:75], v[168:171], v[104:107], v[72:75]
    v_mfma_f32_16x16x32_bf16 v[76:79], v[172:175], v[104:107], v[76:79]
    v_mfma_f32_16x16x32_bf16 v[88:91], v[168:171], v[108:111], v[88:91]
    v_mfma_f32_16x16x32_bf16 v[92:95], v[172:175], v[108:111], v[92:95]
    s_waitcnt vmcnt(0)
    v_mfma_f32_16x16x32_bf16 v[32:35], v[176:179], v[112:115], v[32:35]
    v_mfma_f32_16x16x32_bf16 v[36:39], v[180:183], v[112:115], v[36:39]
    v_mfma_f32_16x16x32_bf16 v[40:43], v[184:187], v[112:115], v[40:43]
    v_mfma_f32_16x16x32_bf16 v[44:47], v[188:191], v[112:115], v[44:47]
    v_mfma_f32_16x16x32_bf16 v[48:51], v[176:179], v[116:119], v[48:51]
    v_mfma_f32_16x16x32_bf16 v[64:67], v[176:179], v[120:123], v[64:67]
    v_mfma_f32_16x16x32_bf16 v[80:83], v[176:179], v[124:127], v[80:83]
    v_mfma_f32_16x16x32_bf16 v[52:55], v[180:183], v[116:119], v[52:55]
    v_mfma_f32_16x16x32_bf16 v[56:59], v[184:187], v[116:119], v[56:59]
    v_mfma_f32_16x16x32_bf16 v[60:63], v[188:191], v[116:119], v[60:63]
    v_mfma_f32_16x16x32_bf16 v[68:71], v[180:183], v[120:123], v[68:71]
    v_mfma_f32_16x16x32_bf16 v[84:87], v[180:183], v[124:127], v[84:87]
    v_mfma_f32_16x16x32_bf16 v[72:75], v[184:187], v[120:123], v[72:75]
    v_mfma_f32_16x16x32_bf16 v[76:79], v[188:191], v[120:123], v[76:79]
    v_mfma_f32_16x16x32_bf16 v[88:91], v[184:187], v[124:127], v[88:91]
    v_mfma_f32_16x16x32_bf16 v[92:95], v[188:191], v[124:127], v[92:95]
    s_nop 7
    ds_write_b128 v8, v[48:51] offset:16384
    ds_write_b128 v8, v[52:55] offset:17408
    ds_write_b128 v8, v[56:59] offset:18432
    ds_write_b128 v8, v[60:63] offset:19456
    ds_write_b128 v8, v[64:67] offset:32768
    ds_write_b128 v8, v[68:71] offset:33792
    ds_write_b128 v8, v[72:75] offset:34816
    ds_write_b128 v8, v[76:79] offset:35840
    ds_write_b128 v8, v[80:83] offset:49152
    ds_write_b128 v8, v[84:87] offset:50176
    ds_write_b128 v8, v[88:91] offset:51200
    ds_write_b128 v8, v[92:95] offset:52224
    s_waitcnt lgkmcnt(0)
    s_barrier
    ds_read_b128 v[96:99], v9 offset:16384
    ds_read_b128 v[100:103], v10 offset:32768
    ds_read_b128 v[104:107], v11 offset:49152
    ds_read_b32 v160, v7 offset:4096
    ds_read_b128 v[144:147], v6 offset:0
    ds_read_b128 v[108:111], v9 offset:17408
    ds_read_b128 v[112:115], v10 offset:33792
    ds_read_b128 v[116:119], v11 offset:50176
    ds_read_b128 v[148:151], v6 offset:1024
    ds_read_b128 v[120:123], v9 offset:18432
    ds_read_b128 v[124:127], v10 offset:34816
    ds_read_b128 v[128:131], v11 offset:51200
    ds_read_b128 v[152:155], v6 offset:2048
    ds_read_b128 v[132:135], v9 offset:19456
    ds_read_b128 v[136:139], v10 offset:35840
    ds_read_b128 v[140:143], v11 offset:52224
    ds_read_b128 v[156:159], v6 offset:3072
    s_waitcnt lgkmcnt(12)
    v_pk_add_f32 v[96:97], v[96:97], v[100:101]
    v_pk_add_f32 v[98:99], v[98:99], v[102:103]
    v_pk_add_f32 v[32:33], v[32:33], v[104:105]
    v_pk_add_f32 v[34:35], v[34:35], v[106:107]
    v_pk_add_f32 v[32:33], v[32:33], v[96:97]
    v_pk_add_f32 v[34:35], v[34:35], v[98:99]
    v_fma_f32 v32, v160, v32, v144
    v_fma_f32 v33, v160, v33, v145
    v_fma_f32 v34, v160, v34, v146
    v_fma_f32 v35, v160, v35, v147
    v_cvt_pk_bf16_f32 v96, v32, v33
    v_cvt_pk_bf16_f32 v97, v34, v35
    s_waitcnt lgkmcnt(8)
    v_pk_add_f32 v[108:109], v[108:109], v[112:113]
    v_pk_add_f32 v[110:111], v[110:111], v[114:115]
    v_pk_add_f32 v[36:37], v[36:37], v[116:117]
    v_pk_add_f32 v[38:39], v[38:39], v[118:119]
    v_pk_add_f32 v[36:37], v[36:37], v[108:109]
    v_pk_add_f32 v[38:39], v[38:39], v[110:111]
    v_fma_f32 v36, v160, v36, v148
    v_fma_f32 v37, v160, v37, v149
    v_fma_f32 v38, v160, v38, v150
    v_fma_f32 v39, v160, v39, v151
    v_cvt_pk_bf16_f32 v98, v36, v37
    v_cvt_pk_bf16_f32 v99, v38, v39
    s_nop 1
    v_permlane16_swap_b32 v96, v98
    v_permlane16_swap_b32 v97, v99
    buffer_store_dwordx4 v[96:99], v5, s[44:47], 0 offen offset:0
    s_waitcnt lgkmcnt(4)
    v_pk_add_f32 v[120:121], v[120:121], v[124:125]
    v_pk_add_f32 v[122:123], v[122:123], v[126:127]
    v_pk_add_f32 v[40:41], v[40:41], v[128:129]
    v_pk_add_f32 v[42:43], v[42:43], v[130:131]
    v_pk_add_f32 v[40:41], v[40:41], v[120:121]
    v_pk_add_f32 v[42:43], v[42:43], v[122:123]
    v_fma_f32 v40, v160, v40, v152
    v_fma_f32 v41, v160, v41, v153
    v_fma_f32 v42, v160, v42, v154
    v_fma_f32 v43, v160, v43, v155
    v_cvt_pk_bf16_f32 v120, v40, v41
    v_cvt_pk_bf16_f32 v121, v42, v43
    s_waitcnt lgkmcnt(0)
    v_pk_add_f32 v[132:133], v[132:133], v[136:137]
    v_pk_add_f32 v[134:135], v[134:135], v[138:139]
    v_pk_add_f32 v[44:45], v[44:45], v[140:141]
    v_pk_add_f32 v[46:47], v[46:47], v[142:143]
    v_pk_add_f32 v[44:45], v[44:45], v[132:133]
    v_pk_add_f32 v[46:47], v[46:47], v[134:135]
    v_fma_f32 v44, v160, v44, v156
    v_fma_f32 v45, v160, v45, v157
    v_fma_f32 v46, v160, v46, v158
    v_fma_f32 v47, v160, v47, v159
    v_cvt_pk_bf16_f32 v122, v44, v45
    v_cvt_pk_bf16_f32 v123, v46, v47
    s_nop 1
    v_permlane16_swap_b32 v120, v122
    v_permlane16_swap_b32 v121, v123
    buffer_store_dwordx4 v[120:123], v5, s[44:47], 0 offen offset:64
    s_endpgm
L_kg_kernel_m28:
    s_add_u32 m0, s50, 0
    s_nop 0
    buffer_load_dwordx4 v40, s[16:19], 0 offen lds
    s_add_u32 m0, s50, 1024
    s_nop 0
    buffer_load_dwordx4 v41, s[16:19], 0 offen lds
    s_add_u32 m0, s50, 2048
    s_nop 0
    buffer_load_dwordx4 v42, s[16:19], 0 offen lds
    s_add_u32 m0, s50, 3072
    s_nop 0
    buffer_load_dwordx4 v41, s[20:23], 0 offen lds
    s_add_u32 m0, s50, 4096
    s_nop 0
    buffer_load_dwordx4 v42, s[20:23], 0 offen lds
    buffer_load_dwordx2 v[10:11], v43, s[24:27], 0 offen
    s_lshl_b32 s6, s3, 2
    s_add_u32 s6, s6, s4
    s_sub_u32 s6, s6, 28
    s_and_b32 s64, s6, 7
    s_lshr_b32 s6, s6, 3
    s_mul_i32 s6, s6, 14
    s_add_u32 s65, s6, s5
    v_lshrrev_b32 v30, 3, v1
    v_lshlrev_b32 v30, 10, v30
    v_and_b32 v31, 7, v1
    v_lshlrev_b32 v32, 1, v3
    v_xor_b32 v31, v31, v32
    v_lshlrev_b32 v31, 4, v31
    v_add_u32 v30, v30, v31
    s_lshl_b32 s6, s64, 7
    v_add_u32 v32, s6, v30
    v_add_u32 v33, 7168, v32
    v_add_u32 v34, 14336, v32
    v_add_u32 v35, 21504, v32
    v_mov_b32 v30, 163584
    s_lshl_b32 s66, s5, 12
    s_add_u32 s66, s66, 65536
    s_lshl_b32 s67, s65, 15
    s_add_u32 m0, s66, 0
    s_add_u32 s6, s67, 0
    buffer_load_dwordx4 v32, s[36:39], s6 offen offset:0 lds
    buffer_load_dwordx4 v33, s[36:39], s6 offen offset:1024 lds
    buffer_load_dwordx4 v34, s[36:39], s6 offen offset:2048 lds
    buffer_load_dwordx4 v35, s[36:39], s6 offen offset:3072 lds
    s_add_u32 m0, s66, 16384
    s_add_u32 s6, s67, 131072
    buffer_load_dwordx4 v32, s[36:39], s6 offen offset:0 lds
    buffer_load_dwordx4 v33, s[36:39], s6 offen offset:1024 lds
    buffer_load_dwordx4 v34, s[36:39], s6 offen offset:2048 lds
    buffer_load_dwordx4 v35, s[36:39], s6 offen offset:3072 lds
    s_add_u32 m0, s66, 32768
    s_add_u32 s6, s67, 262144
    buffer_load_dwordx4 v32, s[36:39], s6 offen offset:0 lds
    buffer_load_dwordx4 v33, s[36:39], s6 offen offset:1024 lds
    buffer_load_dwordx4 v34, s[36:39], s6 offen offset:2048 lds
    buffer_load_dwordx4 v35, s[36:39], s6 offen offset:3072 lds
    s_add_u32 m0, s66, 49152
    s_add_u32 s6, s67, 393216
    s_add_u32 s7, s67, 262144
    s_cmp_ge_u32 s5, 2
    s_cselect_b32 s6, s7, s6
    buffer_load_dwordx4 v32, s[36:39], s6 offen offset:0 lds
    buffer_load_dwordx4 v33, s[36:39], s6 offen offset:1024 lds
    buffer_load_dwordx4 v34, s[36:39], s6 offen offset:2048 lds
    buffer_load_dwordx4 v35, s[36:39], s6 offen offset:3072 lds
    v_lshrrev_b32 v12, 2, v2
    v_lshlrev_b32 v12, 7, v12
    v_lshlrev_b32 v13, 1, v3
    v_bfe_u32 v14, v2, 1, 1
    v_add_u32 v13, v13, v14
    v_lshrrev_b32 v14, 3, v2
    v_lshlrev_b32 v14, 2, v14
    v_xor_b32 v13, v13, v14
    v_lshlrev_b32 v13, 4, v13
    v_add_u32 v12, v12, v13
    v_and_b32 v13, 1, v2
    v_lshlrev_b32 v13, 3, v13
    v_add_u32 v12, v12, v13
    s_add_u32 s6, s50, 512
    v_add_u32 v44, s6, v12
    s_lshl_b32 s6, s5, 1
    s_sub_u32 s6, 6, s6
    v_and_b32 v12, 7, v1
    v_xor_b32 v12, s6, v12
    v_lshlrev_b32 v12, 4, v12
    v_lshlrev_b32 v13, 7, v1
    v_add_u32 v12, v12, v13
    v_add_u32 v45, 154368, v12
    v_xor_b32 v46, 16, v45
    v_mov_b32 v29, 0
    s_add_u32 s16, s32, 8388608
    s_addc_u32 s17, s33, 0
    s_mov_b32 s18, 2097152
    s_lshl_b32 s6, s3, 5
    s_add_u32 s6, s6, s4
    s_lshl_b32 s6, s6, 7
    s_lshl_b32 s7, s5, 2
    s_add_u32 s6, s6, s7
    s_add_u32 s20, s6, 32768
    v_lshrrev_b32 v193, 3, v1
    v_and_b32 v194, 7, v1
    v_xor_b32 v195, v194, v193
    v_lshlrev_b32 v195, 4, v195
    v_lshlrev_b32 v192, 7, v193
    v_add_u32 v192, v192, v195
    s_lshl_b32 s6, s5, 11
    s_add_u32 s6, s6, 154368
    v_add_u32 v192, s6, v192
    s_lshl_b32 s6, s3, 6
    s_lshl_b32 s7, s5, 4
    s_add_u32 s6, s6, s7
    s_lshl_b32 s6, s6, 12
    s_lshl_b32 s7, s4, 7
    s_sub_u32 s6, s6, s7
    s_add_u32 s6, s6, 3968
    v_lshlrev_b32 v193, 12, v193
    v_lshlrev_b32 v194, 4, v194
    v_add_u32 v193, v193, v194
    v_add_u32 v193, s6, v193
    v_add_u32 v194, 0x8000, v193
    s_waitcnt vmcnt(16)
    ds_read_b64_tr_b16 v[64:65], v44 offset:0
    ds_read_b64_tr_b16 v[66:67], v44 offset:512
    ds_read_b64_tr_b16 v[68:69], v44 offset:1024
    ds_read_b64_tr_b16 v[70:71], v44 offset:1536
    ds_read_b64_tr_b16 v[72:73], v44 offset:2048
    ds_read_b64_tr_b16 v[80:81], v44 offset:2560
    ds_read_b64_tr_b16 v[82:83], v44 offset:3072
    ds_read_b64_tr_b16 v[84:85], v44 offset:3584
    ds_read_b64_tr_b16 v[86:87], v44 offset:4096
    v_alignbit_b32 v16, v10, v10, 16
    v_alignbit_b32 v17, v11, v11, 16
    s_waitcnt lgkmcnt(4)
    v_alignbit_b32 v91, v65, v64, 16
    v_alignbit_b32 v92, v66, v65, 16
    v_alignbit_b32 v93, v67, v66, 16
    v_alignbit_b32 v94, v68, v67, 16
    v_alignbit_b32 v95, v69, v68, 16
    v_alignbit_b32 v96, v70, v69, 16
    v_alignbit_b32 v97, v71, v70, 16
    v_alignbit_b32 v98, v72, v71, 16
    v_alignbit_b32 v99, v73, v72, 16
    v_dot2_f32_bf16 v100, v92, v16, 0
    v_dot2_f32_bf16 v101, v66, v16, 0
    v_dot2_f32_bf16 v102, v93, v16, 0
    v_dot2_f32_bf16 v103, v67, v16, 0
    v_dot2_f32_bf16 v104, v94, v16, 0
    v_dot2_f32_bf16 v105, v68, v16, 0
    v_dot2_f32_bf16 v106, v95, v16, 0
    v_dot2_f32_bf16 v107, v69, v16, 0
    v_dot2_f32_bf16 v108, v96, v16, 0
    v_dot2_f32_bf16 v109, v70, v16, 0
    v_dot2_f32_bf16 v110, v97, v16, 0
    v_dot2_f32_bf16 v111, v71, v16, 0
    v_dot2_f32_bf16 v112, v98, v16, 0
    v_dot2_f32_bf16 v113, v72, v16, 0
    v_dot2_f32_bf16 v114, v99, v16, 0
    v_dot2_f32_bf16 v115, v73, v16, 0
    v_dot2_f32_bf16 v100, v91, v17, v100
    v_dot2_f32_bf16 v101, v65, v17, v101
    v_dot2_f32_bf16 v102, v92, v17, v102
    v_dot2_f32_bf16 v103, v66, v17, v103
    v_dot2_f32_bf16 v104, v93, v17, v104
    v_dot2_f32_bf16 v105, v67, v17, v105
    v_dot2_f32_bf16 v106, v94, v17, v106
    v_dot2_f32_bf16 v107, v68, v17, v107
    v_dot2_f32_bf16 v108, v95, v17, v108
    v_dot2_f32_bf16 v109, v69, v17, v109
    v_dot2_f32_bf16 v110, v96, v17, v110
    v_dot2_f32_bf16 v111, v70, v17, v111
    v_dot2_f32_bf16 v112, v97, v17, v112
    v_dot2_f32_bf16 v113, v71, v17, v113
    v_dot2_f32_bf16 v114, v98, v17, v114
    v_dot2_f32_bf16 v115, v72, v17, v115
    s_waitcnt lgkmcnt(0)
    v_lshlrev_b32 v120, 16, v80
    v_and_b32 v121, 0xffff0000, v80
    v_lshlrev_b32 v122, 16, v81
    v_and_b32 v123, 0xffff0000, v81
    v_lshlrev_b32 v124, 16, v82
    v_and_b32 v125, 0xffff0000, v82
    v_lshlrev_b32 v126, 16, v83
    v_and_b32 v127, 0xffff0000, v83
    v_lshlrev_b32 v128, 16, v84
    v_and_b32 v129, 0xffff0000, v84
    v_lshlrev_b32 v130, 16, v85
    v_and_b32 v131, 0xffff0000, v85
    v_lshlrev_b32 v132, 16, v86
    v_and_b32 v133, 0xffff0000, v86
    v_lshlrev_b32 v134, 16, v87
    v_and_b32 v135, 0xffff0000, v87
    v_mul_f32 v100, v100, v120
    v_mul_f32 v101, v101, v121
    v_mul_f32 v102, v102, v122
    v_mul_f32 v103, v103, v123
    v_mul_f32 v104, v104, v124
    v_mul_f32 v105, v105, v125
    v_mul_f32 v106, v106, v126
    v_mul_f32 v107, v107, v127
    v_mul_f32 v108, v108, v128
    v_mul_f32 v109, v109, v129
    v_mul_f32 v110, v110, v130
    v_mul_f32 v111, v111, v131
    v_mul_f32 v112, v112, v132
    v_mul_f32 v113, v113, v133
    v_mul_f32 v114, v114, v134
    v_mul_f32 v115, v115, v135
    v_cvt_pk_bf16_f32 v140, v115, v114
    v_cvt_pk_bf16_f32 v141, v113, v112
    v_cvt_pk_bf16_f32 v142, v111, v110
    v_cvt_pk_bf16_f32 v143, v109, v108
    v_cvt_pk_bf16_f32 v144, v107, v106
    v_cvt_pk_bf16_f32 v145, v105, v104
    v_cvt_pk_bf16_f32 v146, v103, v102
    v_cvt_pk_bf16_f32 v147, v101, v100
    ds_write_b128 v45, v[140:143]
    ds_write_b128 v46, v[144:147]
    s_waitcnt lgkmcnt(0)
    v_mov_b32 v31, 1
    s_mov_b64 exec, 1
    ds_add_u32 v30, v31 offset:8
    s_mov_b64 exec, -1
    s_mov_b32 s68, 0
L_kg_kernel_tb28:
    ds_read_b32 v31, v30 offset:8
    s_waitcnt lgkmcnt(0)
    v_readfirstlane_b32 s69, v31
    s_cmp_ge_u32 s69, 4
    s_cbranch_scc1 L_kg_kernel_tb28_ok
    s_add_u32 s68, s68, 1
    s_cmp_lt_u32 s68, 3200000
    s_cbranch_scc1 L_kg_kernel_tb28
L_kg_kernel_tb28_ok:
    ds_read_b128 v[196:199], v192
    ds_read_b128 v[200:203], v192 offset:1024
    s_waitcnt lgkmcnt(0)
    buffer_load_dword v185, v29, s[60:63], 0 offen sc1
    buffer_store_dwordx4 v[196:199], v193, s[16:19], 0 offen sc1
    buffer_store_dwordx4 v[200:203], v194, s[16:19], 0 offen sc1
    v_mov_b32 v31, 1
    s_mov_b64 exec, 1
    ds_add_u32 v30, v31 offset:20
    s_mov_b64 exec, -1
    v_lshrrev_b32 v20, 2, v2
    v_lshlrev_b32 v21, 2, v3
    v_add_u32 v21, v21, v20
    v_lshlrev_b32 v21, 7, v21
    v_lshlrev_b32 v22, 1, v3
    v_lshrrev_b32 v23, 3, v2
    v_add_u32 v22, v22, v23
    v_and_b32 v22, 3, v22
    v_lshlrev_b32 v22, 5, v22
    v_bfe_u32 v23, v2, 1, 1
    v_lshlrev_b32 v23, 4, v23
    v_add_u32 v21, v21, v23
    v_and_b32 v23, 1, v2
    v_lshlrev_b32 v23, 3, v23
    v_add_u32 v21, v21, v23
    v_add_u32 v21, s66, v21
    v_xor_b32 v23, 0, v22
    v_add_u32 v34, v21, v23
    v_xor_b32 v23, 32, v22
    v_add_u32 v35, v21, v23
    v_xor_b32 v23, 64, v22
    v_add_u32 v36, v21, v23
    v_xor_b32 v23, 96, v22
    v_add_u32 v37, v21, v23
    s_mul_i32 s6, s64, 56
    s_add_u32 s6, s6, s65
    s_lshl_b32 s6, s6, 12
    v_add_u32 v38, s6, v4
    s_waitcnt vmcnt(0)
    v_readfirstlane_b32 s54, v185
    s_cmp_lg_u32 s54, 0
    s_cbranch_scc1 L_kg_kernel_nm28_ok
    s_mov_b32 s68, 0
L_kg_kernel_nm28:
    buffer_load_dword v185, v29, s[60:63], 0 offen sc1
    s_waitcnt vmcnt(0)
    v_readfirstlane_b32 s54, v185
    s_cmp_lg_u32 s54, 0
    s_cbranch_scc1 L_kg_kernel_nm28_ok
    s_add_u32 s68, s68, 1
    s_cmp_lt_u32 s68, 200000
    s_cbranch_scc1 L_kg_kernel_nm28
L_kg_kernel_nm28_ok:
    v_mov_b32 v31, s54
    s_mov_b64 exec, 1
    buffer_store_dword v31, v29, s[56:59], s20 offen sc1
    s_mov_b64 exec, -1
    ds_read_b64_tr_b16 v[64:65], v34 offset:0
    ds_read_b64_tr_b16 v[66:67], v34 offset:2048
    ds_read_b64_tr_b16 v[68:69], v35 offset:0
    ds_read_b64_tr_b16 v[70:71], v35 offset:2048
    ds_read_b64_tr_b16 v[72:73], v36 offset:0
    ds_read_b64_tr_b16 v[74:75], v36 offset:2048
    ds_read_b64_tr_b16 v[76:77], v37 offset:0
    ds_read_b64_tr_b16 v[78:79], v37 offset:2048
    s_mov_b32 s6, 0
    s_waitcnt lgkmcnt(6)
    buffer_store_dwordx4 v[64:67], v38, s[40:43], s6 offen offset:0 sc1
    s_waitcnt lgkmcnt(4)
    buffer_store_dwordx4 v[68:71], v38, s[40:43], s6 offen offset:1024 sc1
    s_waitcnt lgkmcnt(2)
    buffer_store_dwordx4 v[72:75], v38, s[40:43], s6 offen offset:2048 sc1
    s_waitcnt lgkmcnt(0)
    buffer_store_dwordx4 v[76:79], v38, s[40:43], s6 offen offset:3072 sc1
    ds_read_b64_tr_b16 v[80:81], v34 offset:16384
    ds_read_b64_tr_b16 v[82:83], v34 offset:18432
    ds_read_b64_tr_b16 v[84:85], v35 offset:16384
    ds_read_b64_tr_b16 v[86:87], v35 offset:18432
    ds_read_b64_tr_b16 v[88:89], v36 offset:16384
    ds_read_b64_tr_b16 v[90:91], v36 offset:18432
    ds_read_b64_tr_b16 v[92:93], v37 offset:16384
    ds_read_b64_tr_b16 v[94:95], v37 offset:18432
    s_mov_b32 s6, 16384
    s_waitcnt lgkmcnt(6)
    buffer_store_dwordx4 v[80:83], v38, s[40:43], s6 offen offset:0 sc1
    s_waitcnt lgkmcnt(4)
    buffer_store_dwordx4 v[84:87], v38, s[40:43], s6 offen offset:1024 sc1
    s_waitcnt lgkmcnt(2)
    buffer_store_dwordx4 v[88:91], v38, s[40:43], s6 offen offset:2048 sc1
    s_waitcnt lgkmcnt(0)
    buffer_store_dwordx4 v[92:95], v38, s[40:43], s6 offen offset:3072 sc1
    ds_read_b64_tr_b16 v[96:97], v34 offset:32768
    ds_read_b64_tr_b16 v[98:99], v34 offset:34816
    ds_read_b64_tr_b16 v[100:101], v35 offset:32768
    ds_read_b64_tr_b16 v[102:103], v35 offset:34816
    ds_read_b64_tr_b16 v[104:105], v36 offset:32768
    ds_read_b64_tr_b16 v[106:107], v36 offset:34816
    ds_read_b64_tr_b16 v[108:109], v37 offset:32768
    ds_read_b64_tr_b16 v[110:111], v37 offset:34816
    s_mov_b32 s6, 32768
    s_waitcnt lgkmcnt(6)
    buffer_store_dwordx4 v[96:99], v38, s[40:43], s6 offen offset:0 sc1
    s_waitcnt lgkmcnt(4)
    buffer_store_dwordx4 v[100:103], v38, s[40:43], s6 offen offset:1024 sc1
    s_waitcnt lgkmcnt(2)
    buffer_store_dwordx4 v[104:107], v38, s[40:43], s6 offen offset:2048 sc1
    s_waitcnt lgkmcnt(0)
    buffer_store_dwordx4 v[108:111], v38, s[40:43], s6 offen offset:3072 sc1
    s_cmp_ge_u32 s5, 2
    s_cbranch_scc1 L_kg_kernel_w2done
    ds_read_b64_tr_b16 v[112:113], v34 offset:49152
    ds_read_b64_tr_b16 v[114:115], v34 offset:51200
    ds_read_b64_tr_b16 v[116:117], v35 offset:49152
    ds_read_b64_tr_b16 v[118:119], v35 offset:51200
    ds_read_b64_tr_b16 v[120:121], v36 offset:49152
    ds_read_b64_tr_b16 v[122:123], v36 offset:51200
    ds_read_b64_tr_b16 v[124:125], v37 offset:49152
    ds_read_b64_tr_b16 v[126:127], v37 offset:51200
    s_mov_b32 s6, 49152
    s_waitcnt lgkmcnt(6)
    buffer_store_dwordx4 v[112:115], v38, s[40:43], s6 offen offset:0 sc1
    s_waitcnt lgkmcnt(4)
    buffer_store_dwordx4 v[116:119], v38, s[40:43], s6 offen offset:1024 sc1
    s_waitcnt lgkmcnt(2)
    buffer_store_dwordx4 v[120:123], v38, s[40:43], s6 offen offset:2048 sc1
    s_waitcnt lgkmcnt(0)
    buffer_store_dwordx4 v[124:127], v38, s[40:43], s6 offen offset:3072 sc1
L_kg_kernel_w2done:
    v_mov_b32 v31, 1
    s_mov_b64 exec, 1
    ds_add_u32 v30, v31 offset:12
    s_mov_b64 exec, -1
    s_and_b32 s6, s3, 3
    s_lshl_b32 s6, s6, 3
    s_lshr_b32 s7, s3, 2
    s_lshl_b32 s7, s7, 2
    s_add_u32 s6, s6, s7
    s_and_b32 s7, s4, 3
    s_add_u32 s68, s6, s7
    s_lshr_b32 s69, s4, 2
    s_mul_i32 s6, s5, 14
    s_mul_i32 s7, s69, 56
    s_add_u32 s7, s7, s6
    s_lshl_b32 s7, s7, 12
    v_add_u32 v22, s7, v4
    s_mul_i32 s7, s68, 56
    s_add_u32 s7, s7, s6
    s_lshl_b32 s7, s7, 12
    s_add_u32 s6, s5, 0
    s_and_b32 s6, s6, 3
    s_lshl_b32 s6, s6, 10
    s_add_u32 s6, s6, s7
    v_add_u32 v23, s6, v4
    s_add_u32 s6, s5, 1
    s_and_b32 s6, s6, 3
    s_lshl_b32 s6, s6, 10
    s_add_u32 s6, s6, s7
    v_add_u32 v24, s6, v4
    s_add_u32 s6, s5, 2
    s_and_b32 s6, s6, 3
    s_lshl_b32 s6, s6, 10
    s_add_u32 s6, s6, s7
    v_add_u32 v25, s6, v4
    s_add_u32 s6, s5, 3
    s_and_b32 s6, s6, 3
    s_lshl_b32 s6, s6, 10
    s_add_u32 s6, s6, s7
    v_add_u32 v26, s6, v4
    v_min_u32 v27, 6, v1
    s_mul_i32 s6, s5, 7
    v_add_u32 v27, s6, v27
    v_lshrrev_b32 v28, 1, v27
    v_lshlrev_b32 v28, 7, v28
    v_and_b32 v27, 1, v27
    v_lshlrev_b32 v27, 2, v27
    v_add_u32 v27, v27, v28
    s_lshr_b32 s6, s68, 1
    s_mul_i32 s6, s6, 14
    s_lshl_b32 s6, s6, 7
    s_and_b32 s7, s68, 1
    s_lshl_b32 s7, s7, 3
    s_add_u32 s6, s6, s7
    v_add_u32 v27, s6, v27
    s_lshl_b32 s6, s5, 3
    s_add_u32 s6, s6, s69
    s_lshl_b32 s6, s6, 7
    s_add_u32 s6, s6, 135168
    v_and_b32 v28, 3, v1
    v_lshlrev_b32 v28, 2, v28
    v_add_u32 v28, s6, v28
    v_mov_b32 v29, 0
    s_lshl_b32 s6, s68, 6
    s_lshl_b32 s7, s5, 4
    s_add_u32 s6, s6, s7
    v_add_u32 v5, s6, v2
    v_lshlrev_b32 v5, 10, v5
    v_lshrrev_b32 v6, 1, v3
    v_lshlrev_b32 v6, 4, v6
    v_and_b32 v7, 1, v3
    v_lshlrev_b32 v7, 5, v7
    v_add_u32 v6, v6, v7
    s_lshl_b32 s6, s69, 7
    v_add_u32 v6, s6, v6
    v_add_u32 v5, v5, v6
    s_lshr_b32 s6, s5, 1
    s_mul_i32 s6, s6, 16640
    s_sub_u32 s6, 18688, s6
    s_and_b32 s7, s5, 1
    s_lshl_b32 s7, s7, 13
    s_add_u32 s6, s6, s7
    v_add_u32 v6, s6, v4
    v_lshlrev_b32 v7, 2, v1
    v_add_u32 v7, s6, v7
    s_lshl_b32 s6, s3, 2
    s_add_u32 s6, s6, s4
    s_sub_u32 s6, s6, 28
    s_lshl_b32 s6, s6, 7
    s_lshl_b32 s7, s5, 2
    s_add_u32 s6, s6, s7
    s_add_u32 s55, s6, 135168
    s_waitcnt vmcnt(0)
    v_mov_b32 v31, s54
    s_mov_b64 exec, 1
    buffer_store_dword v31, v29, s[56:59], s55 offen sc1
    s_mov_b64 exec, -1
    s_mov_b32 s68, 0
L_kg_kernel_wq:
    buffer_load_dword v184, v28, s[56:59], 0 offen sc1
    buffer_load_dword v185, v29, s[60:63], 0 offen sc1
    s_waitcnt vmcnt(0)
    v_readfirstlane_b32 s54, v185
    s_nop 1
    v_cmp_eq_u32 vcc, s54, v184
    s_cmp_eq_u32 s54, 0
    s_nop 1
    s_cselect_b64 s[6:7], 0, vcc
    s_cmp_eq_u64 s[6:7], -1
    s_cbranch_scc1 L_kg_kernel_wq_ok
    s_add_u32 s68, s68, 1
    s_cmp_lt_u32 s68, 200000
    s_cbranch_scc1 L_kg_kernel_wq
L_kg_kernel_wq_ok:
    s_lshl_b32 s6, s5, 12
    s_add_u32 s7, s6, 33280
    v_add_u32 v12, s7, v4
    v_add_u32 v13, 49152, v12
    s_add_u32 s6, s6, 16896
    v_add_u32 v8, s6, v4
    s_sub_u32 s6, s5, 1
    s_and_b32 s6, s6, 3
    s_lshl_b32 s6, s6, 12
    s_add_u32 s6, s6, 16896
    v_add_u32 v9, s6, v4
    s_sub_u32 s6, s5, 2
    s_and_b32 s6, s6, 3
    s_lshl_b32 s6, s6, 12
    s_add_u32 s6, s6, 16896
    v_add_u32 v10, s6, v4
    s_sub_u32 s6, s5, 3
    s_and_b32 s6, s6, 3
    s_lshl_b32 s6, s6, 12
    s_add_u32 s6, s6, 16896
    v_add_u32 v11, s6, v4
    s_mov_b32 s51, 0
    s_mov_b32 s68, 0
L_kg_kernel_p1db:
    ds_read_b32 v31, v30 offset:12
    s_waitcnt lgkmcnt(0)
    v_readfirstlane_b32 s69, v31
    s_cmp_ge_u32 s69, 4
    s_cbranch_scc1 L_kg_kernel_p1db_ok
    s_add_u32 s68, s68, 1
    s_cmp_lt_u32 s68, 3200000
    s_cbranch_scc1 L_kg_kernel_p1db
L_kg_kernel_p1db_ok:
    s_mov_b32 s68, 0
L_kg_kernel_ystb:
    ds_read_b32 v31, v30 offset:44
    s_waitcnt lgkmcnt(0)
    v_readfirstlane_b32 s69, v31
    s_cmp_ge_u32 s69, 4
    s_cbranch_scc1 L_kg_kernel_ystb_ok
    s_add_u32 s68, s68, 1
    s_cmp_lt_u32 s68, 3200000
    s_cbranch_scc1 L_kg_kernel_ystb
L_kg_kernel_ystb_ok:
    s_lshl_b32 s6, s5, 12
    s_add_u32 m0, s6, 33280
    s_mov_b32 s50, 24576
    buffer_load_dwordx4 v22, s[40:43], s50 offen offset:0 sc1 lds
    buffer_load_dwordx4 v22, s[40:43], s50 offen offset:1024 sc1 lds
    buffer_load_dwordx4 v22, s[40:43], s50 offen offset:2048 sc1 lds
    buffer_load_dwordx4 v22, s[40:43], s50 offen offset:3072 sc1 lds
    s_lshl_b32 s6, s5, 12
    s_add_u32 m0, s6, 49664
    s_mov_b32 s50, 28672
    buffer_load_dwordx4 v22, s[40:43], s50 offen offset:0 sc1 lds
    buffer_load_dwordx4 v22, s[40:43], s50 offen offset:1024 sc1 lds
    buffer_load_dwordx4 v22, s[40:43], s50 offen offset:2048 sc1 lds
    buffer_load_dwordx4 v22, s[40:43], s50 offen offset:3072 sc1 lds
    s_lshl_b32 s6, s5, 12
    s_add_u32 m0, s6, 66048
    s_mov_b32 s50, 32768
    buffer_load_dwordx4 v22, s[40:43], s50 offen offset:0 sc1 lds
    buffer_load_dwordx4 v22, s[40:43], s50 offen offset:1024 sc1 lds
    buffer_load_dwordx4 v22, s[40:43], s50 offen offset:2048 sc1 lds
    buffer_load_dwordx4 v22, s[40:43], s50 offen offset:3072 sc1 lds
    s_lshl_b32 s6, s5, 12
    s_add_u32 m0, s6, 82432
    s_mov_b32 s50, 36864
    buffer_load_dwordx4 v22, s[40:43], s50 offen offset:0 sc1 lds
    buffer_load_dwordx4 v22, s[40:43], s50 offen offset:1024 sc1 lds
    buffer_load_dwordx4 v22, s[40:43], s50 offen offset:2048 sc1 lds
    buffer_load_dwordx4 v22, s[40:43], s50 offen offset:3072 sc1 lds
    s_lshl_b32 s6, s5, 12
    s_add_u32 m0, s6, 98816
    s_mov_b32 s50, 40960
    buffer_load_dwordx4 v22, s[40:43], s50 offen offset:0 sc1 lds
    buffer_load_dwordx4 v22, s[40:43], s50 offen offset:1024 sc1 lds
    buffer_load_dwordx4 v22, s[40:43], s50 offen offset:2048 sc1 lds
    buffer_load_dwordx4 v22, s[40:43], s50 offen offset:3072 sc1 lds
    s_lshl_b32 s6, s5, 12
    s_add_u32 m0, s6, 115200
    s_mov_b32 s50, 45056
    buffer_load_dwordx4 v22, s[40:43], s50 offen offset:0 sc1 lds
    buffer_load_dwordx4 v22, s[40:43], s50 offen offset:1024 sc1 lds
    buffer_load_dwordx4 v22, s[40:43], s50 offen offset:2048 sc1 lds
    buffer_load_dwordx4 v22, s[40:43], s50 offen offset:3072 sc1 lds
    s_mov_b32 s50, 0
    buffer_load_dwordx4 v[160:163], v22, s[40:43], s50 offen offset:0 sc1
    buffer_load_dwordx4 v[164:167], v22, s[40:43], s50 offen offset:1024 sc1
    buffer_load_dwordx4 v[168:171], v22, s[40:43], s50 offen offset:2048 sc1
    buffer_load_dwordx4 v[172:175], v22, s[40:43], s50 offen offset:3072 sc1
    s_mov_b32 s50, 4096
    buffer_load_dwordx4 v[176:179], v22, s[40:43], s50 offen offset:0 sc1
    buffer_load_dwordx4 v[180:183], v22, s[40:43], s50 offen offset:1024 sc1
    buffer_load_dwordx4 v[184:187], v22, s[40:43], s50 offen offset:2048 sc1
    buffer_load_dwordx4 v[188:191], v22, s[40:43], s50 offen offset:3072 sc1
    s_mov_b32 s50, 8192
    buffer_load_dwordx4 v[192:195], v22, s[40:43], s50 offen offset:0 sc1
    buffer_load_dwordx4 v[196:199], v22, s[40:43], s50 offen offset:1024 sc1
    buffer_load_dwordx4 v[200:203], v22, s[40:43], s50 offen offset:2048 sc1
    buffer_load_dwordx4 v[204:207], v22, s[40:43], s50 offen offset:3072 sc1
    s_mov_b32 s50, 12288
    buffer_load_dwordx4 v[208:211], v22, s[40:43], s50 offen offset:0 sc1
    buffer_load_dwordx4 v[212:215], v22, s[40:43], s50 offen offset:1024 sc1
    buffer_load_dwordx4 v[216:219], v22, s[40:43], s50 offen offset:2048 sc1
    buffer_load_dwordx4 v[220:223], v22, s[40:43], s50 offen offset:3072 sc1
    buffer_load_dword v31, v27, s[56:59], 0 offen sc1
    s_mov_b32 s50, 16384
    buffer_load_dwordx4 v[224:227], v22, s[40:43], s50 offen offset:0 sc1
    buffer_load_dwordx4 v[228:231], v22, s[40:43], s50 offen offset:1024 sc1
    buffer_load_dwordx4 v[232:235], v22, s[40:43], s50 offen offset:2048 sc1
    buffer_load_dwordx4 v[236:239], v22, s[40:43], s50 offen offset:3072 sc1
    s_mov_b32 s50, 20480
    buffer_load_dwordx4 v[240:243], v22, s[40:43], s50 offen offset:0 sc1
    buffer_load_dwordx4 v[244:247], v22, s[40:43], s50 offen offset:1024 sc1
    buffer_load_dwordx4 v[248:251], v22, s[40:43], s50 offen offset:2048 sc1
    buffer_load_dwordx4 v[252:255], v22, s[40:43], s50 offen offset:3072 sc1
    s_waitcnt vmcnt(8)
    v_cmp_eq_u32 vcc, s54, v31
    s_nop 1
    s_cmp_eq_u64 vcc, -1
    s_cbranch_scc1 L_kg_kernel_hfp_ok
    s_branch L_kg_kernel_p2
L_kg_kernel_aux:
    s_sub_u32 s5, s5, 4
    s_load_dwordx2 s[8:9], s[0:1], 0
    s_load_dwordx2 s[16:17], s[0:1], 112
    s_cmp_ge_u32 s4, 28
    s_cselect_b32 s6, 88, 56
    s_load_dwordx2 s[12:13], s[0:1], s6
    s_load_dwordx2 s[36:37], s[0:1], 32
    s_load_dwordx2 s[44:45], s[0:1], 80
    s_load_dwordx2 s[32:33], s[0:1], 104
    s_load_dwordx2 s[66:67], s[0:1], 40
    s_mov_b32 s10, 2097152
    s_mov_b32 s11, 0x00020000
    s_mov_b32 s18, 2097152
    s_mov_b32 s19, 0x00020000
    s_mov_b32 s22, 8192
    s_mov_b32 s23, 0x00020000
    s_mov_b32 s7, 1835008
    s_cselect_b32 s14, 1024, s7
    s_mov_b32 s15, 0x00020000
    s_mov_b32 s26, 4096
    s_mov_b32 s27, 0x00020000
    s_mov_b32 s30, 139264
    s_mov_b32 s31, 0x00020000
    s_mov_b32 s34, 256
    s_mov_b32 s35, 0x00020000
    s_mov_b32 s38, 8192
    s_mov_b32 s39, 0x00020000
    s_mov_b32 s42, 8192
    s_mov_b32 s43, 0x00020000
    s_mov_b32 s46, 1024
    s_mov_b32 s47, 0x00020000
    s_lshr_b32 s60, s5, 1
    s_and_b32 s59, s5, 1
    s_mul_i32 s6, s60, 16640
    s_sub_u32 s61, 16640, s6
    s_mul_i32 s6, s60, 4608
    s_add_u32 s62, s6, 154368
    s_and_b32 s6, s3, 3
    s_lshl_b32 s6, s6, 3
    s_lshr_b32 s7, s3, 2
    s_lshl_b32 s7, s7, 2
    s_add_u32 s6, s6, s7
    s_and_b32 s7, s4, 3
    s_add_u32 s52, s6, s7
    s_lshr_b32 s53, s4, 2
    s_lshl_b32 s6, s52, 6
    s_lshl_b32 s7, s5, 4
    s_add_u32 s56, s6, s7
    s_lshl_b32 s6, s59, 13
    s_add_u32 s57, s61, s6
    s_lshl_b32 s6, s3, 1
    s_add_u32 s6, s6, s59
    s_lshl_b32 s6, s6, 5
    s_add_u32 s6, s6, s4
    s_lshl_b32 s6, s6, 7
    s_lshl_b32 s7, s60, 2
    s_add_u32 s6, s6, s7
    s_add_u32 s58, s6, 65536
    s_lshl_b32 s6, s3, 5
    s_add_u32 s6, s6, s4
    s_lshl_b32 s6, s6, 7
    s_lshl_b32 s7, s5, 2
    s_add_u32 s6, s6, s7
    s_add_u32 s65, s6, 32768
    v_mov_b32 v30, 163584
    s_and_b32 s6, s3, 3
    s_lshl_b32 s6, s6, 2
    s_and_b32 s7, s4, 3
    s_add_u32 s48, s6, s7
    s_lshr_b32 s6, s3, 2
    s_mul_i32 s6, s6, 7
    s_lshr_b32 s7, s4, 2
    s_add_u32 s49, s6, s7
    s_mov_b32 s54, s3
    s_lshl_b32 s6, s48, 7
    s_lshl_b32 s7, s5, 5
    s_add_u32 s6, s6, s7
    s_lshl_b32 s6, s6, 10
    v_lshrrev_b32 v60, 3, v1
    v_and_b32 v61, 7, v1
    v_xor_b32 v61, v61, v60
    v_lshlrev_b32 v61, 4, v61
    v_lshlrev_b32 v60, 10, v60
    v_add_u32 v60, v60, v61
    v_add_u32 v44, s6, v60
    v_add_u32 v45, 7168, v44
    v_add_u32 v46, 14336, v44
    v_add_u32 v47, 21504, v44
    s_lshl_b32 s6, s5, 4
    s_mul_i32 s6, s6, 3584
    s_lshl_b32 s7, s49, 8
    s_add_u32 s6, s6, s7
    v_lshlrev_b32 v62, 1, v3
    v_xor_b32 v62, v62, v2
    v_lshlrev_b32 v62, 4, v62
    v_mul_u32_u24 v63, 3584, v3
    v_add_u32 v62, v62, v63
    v_add_u32 v48, s6, v62
    v_add_u32 v49, 13312, v48
    v_xor_b32 v62, 128, v48
    v_add_u32 v50, 26624, v62
    v_add_u32 v51, 39936, v62
    s_lshl_b32 s55, s5, 12
    s_waitcnt lgkmcnt(0)
    s_add_u32 s20, s16, 12582912
    s_addc_u32 s21, s17, 0
    s_add_u32 s28, s16, 12648448
    s_addc_u32 s29, s17, 0
    s_lshl_b32 s6, s3, 6
    s_lshl_b32 s7, s4, 1
    s_add_u32 s6, s6, s7
    s_lshl_b32 s64, s6, 1
    s_load_dword s51, s[66:67], s64
    s_lshl_b32 s7, s6, 12
    s_add_u32 s36, s36, s7
    s_addc_u32 s37, s37, 0
    s_add_u32 s24, s16, 10485760
    s_addc_u32 s25, s17, 0
    s_add_u32 s16, s16, 8388608
    s_addc_u32 s17, s17, 0
    s_add_u32 s40, s16, s7
    s_addc_u32 s41, s17, 0
    s_lshl_b32 s6, s60, 12
    s_add_u32 s7, s7, s6
    s_add_u32 s24, s24, s7
    s_addc_u32 s25, s25, 0
    v_mov_b32 v27, 0
    s_barrier
    s_cmp_eq_u32 s2, 0
    s_cselect_b32 s6, s5, 1
    s_cmp_eq_u32 s6, 0
    s_cbranch_scc0 L_kg_kernel_non
    s_memrealtime s[6:7]
    s_waitcnt lgkmcnt(0)
    s_lshl_b32 s6, s6, 1
    s_or_b32 s6, s6, 1
    s_mov_b32 s7, 0
    v_mov_b32 v31, s6
    s_mov_b64 exec, 1
    buffer_store_dword v31, v27, s[32:35], s7 offen sc1
    s_mov_b64 exec, -1
L_kg_kernel_non:
    s_cmp_ge_u32 s4, 28
    s_cbranch_scc1 L_kg_kernel_gate
    s_lshl_b32 s6, s5, 11
    v_add_u32 v26, s6, v4
    buffer_load_dwordx4 v[200:203], v26, s[36:39], 0 offen
    buffer_load_dwordx4 v[204:207], v26, s[36:39], 0 offen offset:1024
    s_add_u32 s6, s54, 2
    s_and_b32 s6, s6, 7
    s_add_u32 m0, s55, 65536
    s_lshl_b32 s7, s6, 7
    buffer_load_dwordx4 v44, s[8:11], s7 offen offset:0 lds
    buffer_load_dwordx4 v45, s[8:11], s7 offen offset:1024 lds
    buffer_load_dwordx4 v46, s[8:11], s7 offen offset:2048 lds
    buffer_load_dwordx4 v47, s[8:11], s7 offen offset:3072 lds
    s_add_u32 m0, s55, 81920
    s_mul_i32 s7, s6, 229376
    buffer_load_dwordx4 v48, s[12:15], s7 offen offset:0 lds
    buffer_load_dwordx4 v49, s[12:15], s7 offen offset:1024 lds
    buffer_load_dwordx4 v50, s[12:15], s7 offen offset:2048 lds
    buffer_load_dwordx4 v51, s[12:15], s7 offen offset:3072 lds
    s_add_u32 s6, s54, 3
    s_and_b32 s6, s6, 7
    s_add_u32 m0, s55, 98304
    s_lshl_b32 s7, s6, 7
    buffer_load_dwordx4 v44, s[8:11], s7 offen offset:0 lds
    buffer_load_dwordx4 v45, s[8:11], s7 offen offset:1024 lds
    buffer_load_dwordx4 v46, s[8:11], s7 offen offset:2048 lds
    buffer_load_dwordx4 v47, s[8:11], s7 offen offset:3072 lds
    s_add_u32 m0, s55, 114688
    s_mul_i32 s7, s6, 229376
    buffer_load_dwordx4 v48, s[12:15], s7 offen offset:0 lds
    buffer_load_dwordx4 v49, s[12:15], s7 offen offset:1024 lds
    buffer_load_dwordx4 v50, s[12:15], s7 offen offset:2048 lds
    buffer_load_dwordx4 v51, s[12:15], s7 offen offset:3072 lds
    s_mov_b32 s68, 0
L_kg_kernel_am1:
    ds_read_b32 v31, v30 offset:4
    s_waitcnt lgkmcnt(0)
    v_readfirstlane_b32 s69, v31
    s_cmp_ge_u32 s69, 4
    s_cbranch_scc1 L_kg_kernel_am1_ok
    s_add_u32 s68, s68, 1
    s_cmp_lt_u32 s68, 3200000
    s_cbranch_scc1 L_kg_kernel_am1
L_kg_kernel_am1_ok:
    s_add_u32 s6, s54, 4
    s_and_b32 s6, s6, 7
    s_add_u32 m0, s55, 0
    s_lshl_b32 s7, s6, 7
    buffer_load_dwordx4 v44, s[8:11], s7 offen offset:0 lds
    buffer_load_dwordx4 v45, s[8:11], s7 offen offset:1024 lds
    buffer_load_dwordx4 v46, s[8:11], s7 offen offset:2048 lds
    buffer_load_dwordx4 v47, s[8:11], s7 offen offset:3072 lds
    s_add_u32 m0, s55, 16384
    s_mul_i32 s7, s6, 229376
    buffer_load_dwordx4 v48, s[12:15], s7 offen offset:0 lds
    buffer_load_dwordx4 v49, s[12:15], s7 offen offset:1024 lds
    buffer_load_dwordx4 v50, s[12:15], s7 offen offset:2048 lds
    buffer_load_dwordx4 v51, s[12:15], s7 offen offset:3072 lds
    s_waitcnt vmcnt(16)
    s_barrier
    s_add_u32 s6, s54, 5
    s_and_b32 s6, s6, 7
    s_add_u32 m0, s55, 32768
    s_lshl_b32 s7, s6, 7
    buffer_load_dwordx4 v44, s[8:11], s7 offen offset:0 lds
    buffer_load_dwordx4 v45, s[8:11], s7 offen offset:1024 lds
    buffer_load_dwordx4 v46, s[8:11], s7 offen offset:2048 lds
    buffer_load_dwordx4 v47, s[8:11], s7 offen offset:3072 lds
    s_add_u32 m0, s55, 49152
    s_mul_i32 s7, s6, 229376
    buffer_load_dwordx4 v48, s[12:15], s7 offen offset:0 lds
    buffer_load_dwordx4 v49, s[12:15], s7 offen offset:1024 lds
    buffer_load_dwordx4 v50, s[12:15], s7 offen offset:2048 lds
    buffer_load_dwordx4 v51, s[12:15], s7 offen offset:3072 lds
    buffer_load_dword v28, v27, s[32:35], 0 offen sc1
    v_sub_u32 v14, 15, v2
    v_and_b32 v15, 3, v14
    v_lshrrev_b32 v14, 2, v14
    v_mul_u32_u24 v15, 4160, v15
    v_lshlrev_b32 v14, 3, v14
    v_sub_u32 v15, v15, v14
    v_lshlrev_b32 v14, 4, v3
    v_add_u32 v15, v15, v14
    s_lshl_b32 s67, s59, 8
    s_add_u32 s6, s61, s67
    s_add_u32 s6, s6, 32
    v_add_u32 v20, s6, v15
    v_lshlrev_b32 v15, 5, v2
    v_sub_u32 v16, v14, v15
    s_add_u32 s6, s62, 480
    s_add_u32 s6, s6, s67
    v_add_u32 v21, s6, v16
    v_lshlrev_b32 v16, 3, v3
    v_add_u32 v16, v16, v15
    s_lshl_b32 s67, s59, 11
    v_lshrrev_b32 v22, 1, v3
    v_lshlrev_b32 v22, 4, v22
    v_add_u32 v22, v22, v15
    v_and_b32 v23, 1, v3
    v_lshlrev_b32 v23, 9, v23
    v_add_u32 v22, v22, v23
    v_add_u32 v22, s67, v22
    s_add_u32 s6, s62, 2552
    s_sub_u32 s6, s6, s67
    v_sub_u32 v23, s6, v16
    s_lshl_b32 s6, s5, 12
    s_add_u32 s6, s6, 131584
    v_add_u32 v24, s6, v4
    s_xor_b32 s6, s5, 1
    s_lshl_b32 s6, s6, 12
    s_add_u32 s6, s6, 131584
    v_add_u32 v25, s6, v4
    v_mov_b32 v27, 0
    v_add_u32 v5, s56, v2
    v_lshlrev_b32 v6, 10, v5
    v_lshlrev_b32 v7, 3, v3
    s_lshl_b32 s6, s53, 7
    v_add_u32 v7, s6, v7
    v_add_u32 v6, v6, v7
    v_lshlrev_b32 v5, 2, v5
    v_lshrrev_b32 v8, 1, v1
    v_lshlrev_b32 v8, 12, v8
    v_and_b32 v9, 1, v1
    v_lshlrev_b32 v9, 4, v9
    v_add_u32 v8, v8, v9
    s_lshl_b32 s6, s53, 18
    s_lshl_b32 s7, s56, 1
    s_add_u32 s6, s6, s7
    v_add_u32 v8, s6, v8
    v_add_u32 v9, 0x20000, v8
    s_lshl_b32 s6, s53, 1
    s_lshr_b32 s7, s52, 4
    s_add_u32 s6, s6, s7
    s_lshl_b32 s6, s6, 12
    s_add_u32 s6, s6, 65536
    v_lshrrev_b32 v10, 1, v1
    v_lshlrev_b32 v10, 7, v10
    v_and_b32 v11, 1, v1
    v_lshlrev_b32 v11, 2, v11
    v_add_u32 v10, v10, v11
    v_add_u32 v10, s6, v10
    s_lshl_b32 s6, s52, 7
    s_add_u32 s6, s6, 131072
    v_and_b32 v11, 3, v1
    v_lshlrev_b32 v11, 2, v11
    v_add_u32 v11, s6, v11
    s_lshl_b32 s6, s5, 1
    s_sub_u32 s6, 32, s6
    v_add_u32 v32, s6, v4
    v_add_u32 v33, 4096, v32
    v_and_b32 v34, 31, v1
    s_add_u32 s6, s5, 16
    v_subrev_u32 v35, s6, v34
    v_lshlrev_b32 v35, 1, v35
    v_lshrrev_b32 v36, 5, v1
    v_lshlrev_b32 v37, 12, v36
    v_add_u32 v37, v37, v35
    v_cmp_gt_i32 vcc, 0, v35
    v_mov_b32 v38, 0x7fffffff
    s_mul_i32 s6, s5, 4160
    v_cndmask_b32 v35, v37, v38, vcc
    v_lshlrev_b32 v34, 1, v34
    v_add_u32 v34, s6, v34
    v_mul_u32_u24 v36, 16640, v36
    v_sub_u32 v36, 16640, v36
    v_add_u32 v34, v34, v36
    s_lshl_b32 s6, s5, 10
    v_add_u32 v36, s6, v4
    v_add_u32 v37, 4096, v36
    v_and_b32 v39, 31, v1
    v_lshlrev_b32 v39, 7, v39
    s_lshl_b32 s6, s3, 12
    s_lshr_b32 s7, s4, 3
    s_lshl_b32 s7, s7, 2
    s_add_u32 s6, s6, s7
    s_add_u32 s6, s6, 32768
    v_add_u32 v39, s6, v39
    s_lshr_b32 s6, s5, 1
    s_mul_i32 s6, s6, 4608
    s_and_b32 s7, s5, 1
    s_lshl_b32 s7, s7, 8
    s_add_u32 s6, s6, s7
    s_add_u32 s6, s6, 158464
    v_lshlrev_b32 v41, 2, v1
    v_add_u32 v41, s6, v41
    s_waitcnt vmcnt(17)
    s_barrier
    s_add_u32 s6, s54, 6
    s_and_b32 s6, s6, 7
    s_add_u32 m0, s55, 65536
    s_lshl_b32 s7, s6, 7
    buffer_load_dwordx4 v44, s[8:11], s7 offen offset:0 lds
    buffer_load_dwordx4 v45, s[8:11], s7 offen offset:1024 lds
    buffer_load_dwordx4 v46, s[8:11], s7 offen offset:2048 lds
    buffer_load_dwordx4 v47, s[8:11], s7 offen offset:3072 lds
    s_add_u32 m0, s55, 81920
    s_mul_i32 s7, s6, 229376
    buffer_load_dwordx4 v48, s[12:15], s7 offen offset:0 lds
    buffer_load_dwordx4 v49, s[12:15], s7 offen offset:1024 lds
    buffer_load_dwordx4 v50, s[12:15], s7 offen offset:2048 lds
    buffer_load_dwordx4 v51, s[12:15], s7 offen offset:3072 lds
    s_waitcnt vmcnt(17)
    s_barrier
    buffer_load_dword v40, v39, s[28:31], 0 offen sc1
    s_add_u32 s6, s54, 7
    s_and_b32 s6, s6, 7
    s_add_u32 m0, s55, 98304
    s_lshl_b32 s7, s6, 7
    buffer_load_dwordx4 v44, s[8:11], s7 offen offset:0 lds
    buffer_load_dwordx4 v45, s[8:11], s7 offen offset:1024 lds
    buffer_load_dwordx4 v46, s[8:11], s7 offen offset:2048 lds
    buffer_load_dwordx4 v47, s[8:11], s7 offen offset:3072 lds
    s_add_u32 m0, s55, 114688
    s_mul_i32 s7, s6, 229376
    buffer_load_dwordx4 v48, s[12:15], s7 offen offset:0 lds
    buffer_load_dwordx4 v49, s[12:15], s7 offen offset:1024 lds
    buffer_load_dwordx4 v50, s[12:15], s7 offen offset:2048 lds
    buffer_load_dwordx4 v51, s[12:15], s7 offen offset:3072 lds
    s_waitcnt vmcnt(17)
    v_readfirstlane_b32 s50, v28
    s_cmp_lg_u32 s50, 0
    s_cbranch_scc1 L_kg_kernel_naa_ok
    s_mov_b32 s68, 0
L_kg_kernel_naa:
    buffer_load_dword v28, v27, s[32:35], 0 offen sc1
    s_waitcnt vmcnt(0)
    v_readfirstlane_b32 s50, v28
    s_cmp_lg_u32 s50, 0
    s_cbranch_scc1 L_kg_kernel_naa_ok
    s_add_u32 s68, s68, 1
    s_cmp_lt_u32 s68, 200000
    s_cbranch_scc1 L_kg_kernel_naa
L_kg_kernel_naa_ok:
    s_barrier
    s_waitcnt vmcnt(8)
    s_barrier
    v_cmp_eq_u32 vcc, s50, v40
    s_nop 1
    s_cmp_eq_u64 vcc, -1
    s_cbranch_scc0 L_kg_kernel_cs
    s_mov_b32 s68, 0
L_kg_kernel_tbdf:
    ds_read_b32 v31, v30 offset:20
    s_waitcnt lgkmcnt(0)
    v_readfirstlane_b32 s69, v31
    s_cmp_ge_u32 s69, 4
    s_cbranch_scc1 L_kg_kernel_tbdf_ok
    s_add_u32 s68, s68, 1
    s_cmp_lt_u32 s68, 3200000
    s_cbranch_scc1 L_kg_kernel_tbdf
L_kg_kernel_tbdf_ok:
    s_lshl_b32 s6, s5, 10
    s_add_u32 m0, s6, 154368
    s_nop 0
    buffer_load_dwordx4 v36, s[40:43], 0 offen sc1 lds
    s_lshl_b32 s6, s5, 10
    s_add_u32 m0, s6, 158976
    s_nop 0
    buffer_load_dwordx4 v37, s[40:43], 0 offen sc1 lds
    s_mul_i32 s6, s5, 4160
    s_add_u32 m0, s6, 16704
    s_nop 0
    buffer_load_dwordx4 v32, s[36:39], 0 offen offset:0 lds
    buffer_load_dwordx4 v32, s[36:39], 0 offen offset:1024 lds
    buffer_load_dwordx4 v32, s[36:39], 0 offen offset:2048 lds
    buffer_load_dwordx4 v32, s[36:39], 0 offen offset:3072 lds
    s_mul_i32 s6, s5, 4160
    s_add_u32 m0, s6, 64
    s_nop 0
    buffer_load_dwordx4 v33, s[36:39], 0 offen offset:0 lds
    buffer_load_dwordx4 v33, s[36:39], 0 offen offset:1024 lds
    buffer_load_dwordx4 v33, s[36:39], 0 offen offset:2048 lds
    buffer_load_dwordx4 v33, s[36:39], 0 offen offset:3072 lds
    buffer_load_ushort v38, v35, s[36:39], 0 offen
    s_add_u32 s12, s16, 2097152
    s_addc_u32 s13, s17, 0
    s_mov_b32 s14, 2097152
    s_mov_b32 s15, 0x00020000
    s_waitcnt vmcnt(11)
    s_barrier
    s_branch L_kg_kernel_cu
L_kg_kernel_cs:
    buffer_load_dword v40, v39, s[28:31], 0 offen sc1
    s_mul_i32 s6, s5, 4160
    s_add_u32 m0, s6, 16704
    s_nop 0
    buffer_load_dwordx4 v32, s[36:39], 0 offen offset:0 lds
    buffer_load_dwordx4 v32, s[36:39], 0 offen offset:1024 lds
    buffer_load_dwordx4 v32, s[36:39], 0 offen offset:2048 lds
    buffer_load_dwordx4 v32, s[36:39], 0 offen offset:3072 lds
    s_mul_i32 s6, s5, 4160
    s_add_u32 m0, s6, 64
    s_nop 0
    buffer_load_dwordx4 v33, s[36:39], 0 offen offset:0 lds
    buffer_load_dwordx4 v33, s[36:39], 0 offen offset:1024 lds
    buffer_load_dwordx4 v33, s[36:39], 0 offen offset:2048 lds
    buffer_load_dwordx4 v33, s[36:39], 0 offen offset:3072 lds
    buffer_load_ushort v38, v35, s[36:39], 0 offen
    s_cmp_ge_u32 s4, 28
    s_cbranch_scc1 L_kg_kernel_nb2
    s_waitcnt vmcnt(10)
    s_barrier
L_kg_kernel_nb2:
    s_add_u32 s12, s16, 2097152
    s_addc_u32 s13, s17, 0
    s_mov_b32 s14, 2097152
    s_mov_b32 s15, 0x00020000
    s_mov_b32 s68, 0
L_kg_kernel_tbd:
    ds_read_b32 v31, v30 offset:20
    s_waitcnt lgkmcnt(0)
    v_readfirstlane_b32 s69, v31
    s_cmp_ge_u32 s69, 4
    s_cbranch_scc1 L_kg_kernel_tbd_ok
    s_add_u32 s68, s68, 1
    s_cmp_lt_u32 s68, 3200000
    s_cbranch_scc1 L_kg_kernel_tbd
L_kg_kernel_tbd_ok:
    s_waitcnt vmcnt(9)
    v_cmp_eq_u32 vcc, s50, v40
    s_nop 1
    s_cmp_eq_u64 vcc, -1
    s_cbranch_scc1 L_kg_kernel_up_ok
    s_mov_b32 s68, 0
L_kg_kernel_up:
    buffer_load_dword v40, v39, s[28:31], 0 offen sc1
    s_waitcnt vmcnt(0)
    v_cmp_eq_u32 vcc, s50, v40
    s_nop 1
    s_cmp_eq_u64 vcc, -1
    s_cbranch_scc1 L_kg_kernel_up_ok
    s_add_u32 s68, s68, 1
    s_cmp_lt_u32 s68, 200000
    s_cbranch_scc1 L_kg_kernel_up
L_kg_kernel_up_ok:
    s_lshl_b32 s6, s5, 10
    s_add_u32 m0, s6, 154368
    s_nop 0
    buffer_load_dwordx4 v36, s[40:43], 0 offen sc1 lds
    s_lshl_b32 s6, s5, 10
    s_add_u32 m0, s6, 158976
    s_nop 0
    buffer_load_dwordx4 v37, s[40:43], 0 offen sc1 lds
L_kg_kernel_cu:
    v_mov_b32 v42, 0
    ds_write_b32 v41, v42
    buffer_load_dwordx2 v[192:193], v6, s[8:11], 0 offen offset:0
    buffer_load_dwordx2 v[194:195], v6, s[8:11], 0 offen offset:32
    buffer_load_dwordx2 v[196:197], v6, s[8:11], 0 offen offset:64
    buffer_load_dwordx2 v[198:199], v6, s[8:11], 0 offen offset:96
    buffer_load_dwordx2 v[200:201], v7, s[44:47], 0 offen offset:0
    buffer_load_dwordx2 v[202:203], v7, s[44:47], 0 offen offset:32
    buffer_load_dwordx2 v[204:205], v7, s[44:47], 0 offen offset:64
    buffer_load_dwordx2 v[206:207], v7, s[44:47], 0 offen offset:96
    s_lshl_b32 s6, s51, 16
    s_and_b32 s7, s51, 0xffff0000
    s_cmp_eq_u32 s60, 0
    s_cselect_b32 s6, s6, s7
    v_mov_b32 v13, s6
    s_waitcnt vmcnt(8)
    ds_write_b16 v34, v38
    s_waitcnt lgkmcnt(0)
    v_mov_b32 v31, 1
    s_mov_b64 exec, 1
    ds_add_u32 v30, v31 offset:16
    s_mov_b64 exec, -1
    s_mov_b32 s68, 0
L_kg_kernel_rdy:
    ds_read_b32 v31, v30 offset:16
    s_waitcnt lgkmcnt(0)
    v_readfirstlane_b32 s69, v31
    s_cmp_ge_u32 s69, 4
    s_cbranch_scc1 L_kg_kernel_rdy_ok
    s_add_u32 s68, s68, 1
    s_cmp_lt_u32 s68, 3200000
    s_cbranch_scc1 L_kg_kernel_rdy
L_kg_kernel_rdy_ok:
    ds_read_b128 v[96:99], v21 offset:3584
    ds_read_b64 v[64:65], v20 offset:0
    ds_read_b64 v[66:67], v20 offset:8
    ds_read_b128 v[100:103], v21 offset:3072
    ds_read_b128 v[104:107], v21 offset:2560
    ds_read_b128 v[108:111], v21 offset:2048
    ds_read_b128 v[112:115], v21 offset:1536
    ds_read_b128 v[116:119], v21 offset:1024
    ds_read_b128 v[120:123], v21 offset:512
    ds_read_b128 v[124:127], v21 offset:0
    ds_read_b64 v[68:69], v20 offset:512
    ds_read_b64 v[70:71], v20 offset:520
    ds_read_b64 v[72:73], v20 offset:1024
    ds_read_b64 v[74:75], v20 offset:1032
    ds_read_b64 v[76:77], v20 offset:1536
    ds_read_b64 v[78:79], v20 offset:1544
    ds_read_b64 v[80:81], v20 offset:2048
    ds_read_b64 v[82:83], v20 offset:2056
    ds_read_b64 v[84:85], v20 offset:2560
    ds_read_b64 v[86:87], v20 offset:2568
    ds_read_b64 v[88:89], v20 offset:3072
    ds_read_b64 v[90:91], v20 offset:3080
    ds_read_b64 v[92:93], v20 offset:3584
    ds_read_b64 v[94:95], v20 offset:3592
    s_waitcnt lgkmcnt(0)
    v_mfma_f32_16x16x32_bf16 v[32:35], v[64:67], v[96:99], 0
    ds_read_b128 v[160:163], v21 offset:3648
    v_mfma_f32_16x16x32_bf16 v[36:39], v[64:67], v[100:103], 0
    ds_read_b64 v[128:129], v20 offset:64
    v_mfma_f32_16x16x32_bf16 v[40:43], v[64:67], v[104:107], 0
    ds_read_b64 v[130:131], v20 offset:72
    v_mfma_f32_16x16x32_bf16 v[44:47], v[64:67], v[108:111], 0
    ds_read_b128 v[164:167], v21 offset:3136
    v_mfma_f32_16x16x32_bf16 v[48:51], v[64:67], v[112:115], 0
    ds_read_b128 v[168:171], v21 offset:2624
    v_mfma_f32_16x16x32_bf16 v[52:55], v[64:67], v[116:119], 0
    ds_read_b128 v[172:175], v21 offset:2112
    v_mfma_f32_16x16x32_bf16 v[56:59], v[64:67], v[120:123], 0
    ds_read_b128 v[176:179], v21 offset:1600
    v_mfma_f32_16x16x32_bf16 v[60:63], v[64:67], v[124:127], 0
    ds_read_b128 v[180:183], v21 offset:1088
    v_mfma_f32_16x16x32_bf16 v[36:39], v[68:71], v[96:99], v[36:39]
    ds_read_b128 v[184:187], v21 offset:576
    v_mfma_f32_16x16x32_bf16 v[40:43], v[68:71], v[100:103], v[40:43]
    ds_read_b128 v[188:191], v21 offset:64
    v_mfma_f32_16x16x32_bf16 v[44:47], v[68:71], v[104:107], v[44:47]
    ds_read_b64 v[132:133], v20 offset:576
    v_mfma_f32_16x16x32_bf16 v[48:51], v[68:71], v[108:111], v[48:51]
    ds_read_b64 v[134:135], v20 offset:584
    v_mfma_f32_16x16x32_bf16 v[52:55], v[68:71], v[112:115], v[52:55]
    ds_read_b64 v[136:137], v20 offset:1088
    v_mfma_f32_16x16x32_bf16 v[56:59], v[68:71], v[116:119], v[56:59]
    ds_read_b64 v[138:139], v20 offset:1096
    v_mfma_f32_16x16x32_bf16 v[60:63], v[68:71], v[120:123], v[60:63]
    ds_read_b64 v[140:141], v20 offset:1600
    v_mfma_f32_16x16x32_bf16 v[40:43], v[72:75], v[96:99], v[40:43]
    ds_read_b64 v[142:143], v20 offset:1608
    v_mfma_f32_16x16x32_bf16 v[44:47], v[72:75], v[100:103], v[44:47]
    ds_read_b64 v[144:145], v20 offset:2112
    v_mfma_f32_16x16x32_bf16 v[48:51], v[72:75], v[104:107], v[48:51]
    ds_read_b64 v[146:147], v20 offset:2120
    v_mfma_f32_16x16x32_bf16 v[52:55], v[72:75], v[108:111], v[52:55]
    ds_read_b64 v[148:149], v20 offset:2624
    v_mfma_f32_16x16x32_bf16 v[56:59], v[72:75], v[112:115], v[56:59]
    ds_read_b64 v[150:151], v20 offset:2632
    v_mfma_f32_16x16x32_bf16 v[60:63], v[72:75], v[116:119], v[60:63]
    ds_read_b64 v[152:153], v20 offset:3136
    v_mfma_f32_16x16x32_bf16 v[44:47], v[76:79], v[96:99], v[44:47]
    ds_read_b64 v[154:155], v20 offset:3144
    v_mfma_f32_16x16x32_bf16 v[48:51], v[76:79], v[100:103], v[48:51]
    ds_read_b64 v[156:157], v20 offset:3648
    v_mfma_f32_16x16x32_bf16 v[52:55], v[76:79], v[104:107], v[52:55]
    ds_read_b64 v[158:159], v20 offset:3656
    v_mfma_f32_16x16x32_bf16 v[56:59], v[76:79], v[108:111], v[56:59]
    v_mfma_f32_16x16x32_bf16 v[60:63], v[76:79], v[112:115], v[60:63]
    v_mfma_f32_16x16x32_bf16 v[48:51], v[80:83], v[96:99], v[48:51]
    v_mfma_f32_16x16x32_bf16 v[52:55], v[80:83], v[100:103], v[52:55]
    v_mfma_f32_16x16x32_bf16 v[56:59], v[80:83], v[104:107], v[56:59]
    v_mfma_f32_16x16x32_bf16 v[60:63], v[80:83], v[108:111], v[60:63]
    v_mfma_f32_16x16x32_bf16 v[52:55], v[84:87], v[96:99], v[52:55]
    v_mfma_f32_16x16x32_bf16 v[56:59], v[84:87], v[100:103], v[56:59]
    v_mfma_f32_16x16x32_bf16 v[60:63], v[84:87], v[104:107], v[60:63]
    v_mfma_f32_16x16x32_bf16 v[56:59], v[88:91], v[96:99], v[56:59]
    v_mfma_f32_16x16x32_bf16 v[60:63], v[88:91], v[100:103], v[60:63]
    v_mfma_f32_16x16x32_bf16 v[60:63], v[92:95], v[96:99], v[60:63]
    s_waitcnt lgkmcnt(0)
    v_mfma_f32_16x16x32_bf16 v[32:35], v[128:131], v[160:163], v[32:35]
    ds_read_b128 v[96:99], v21 offset:3712
    v_mfma_f32_16x16x32_bf16 v[36:39], v[128:131], v[164:167], v[36:39]
    ds_read_b64 v[64:65], v20 offset:128
    v_mfma_f32_16x16x32_bf16 v[40:43], v[128:131], v[168:171], v[40:43]
    ds_read_b64 v[66:67], v20 offset:136
    v_mfma_f32_16x16x32_bf16 v[44:47], v[128:131], v[172:175], v[44:47]
    ds_read_b128 v[100:103], v21 offset:3200
    v_mfma_f32_16x16x32_bf16 v[48:51], v[128:131], v[176:179], v[48:51]
    ds_read_b128 v[104:107], v21 offset:2688
    v_mfma_f32_16x16x32_bf16 v[52:55], v[128:131], v[180:183], v[52:55]
    ds_read_b128 v[108:111], v21 offset:2176
    v_mfma_f32_16x16x32_bf16 v[56:59], v[128:131], v[184:187], v[56:59]
    ds_read_b128 v[112:115], v21 offset:1664
    v_mfma_f32_16x16x32_bf16 v[60:63], v[128:131], v[188:191], v[60:63]
    ds_read_b128 v[116:119], v21 offset:1152
    v_mfma_f32_16x16x32_bf16 v[36:39], v[132:135], v[160:163], v[36:39]
    ds_read_b128 v[120:123], v21 offset:640
    v_mfma_f32_16x16x32_bf16 v[40:43], v[132:135], v[164:167], v[40:43]
    ds_read_b128 v[124:127], v21 offset:128
    v_mfma_f32_16x16x32_bf16 v[44:47], v[132:135], v[168:171], v[44:47]
    ds_read_b64 v[68:69], v20 offset:640
    v_mfma_f32_16x16x32_bf16 v[48:51], v[132:135], v[172:175], v[48:51]
    ds_read_b64 v[70:71], v20 offset:648
    v_mfma_f32_16x16x32_bf16 v[52:55], v[132:135], v[176:179], v[52:55]
    ds_read_b64 v[72:73], v20 offset:1152
    v_mfma_f32_16x16x32_bf16 v[56:59], v[132:135], v[180:183], v[56:59]
    ds_read_b64 v[74:75], v20 offset:1160
    v_mfma_f32_16x16x32_bf16 v[60:63], v[132:135], v[184:187], v[60:63]
    ds_read_b64 v[76:77], v20 offset:1664
    v_mfma_f32_16x16x32_bf16 v[40:43], v[136:139], v[160:163], v[40:43]
    ds_read_b64 v[78:79], v20 offset:1672
    v_mfma_f32_16x16x32_bf16 v[44:47], v[136:139], v[164:167], v[44:47]
    ds_read_b64 v[80:81], v20 offset:2176
    v_mfma_f32_16x16x32_bf16 v[48:51], v[136:139], v[168:171], v[48:51]
    ds_read_b64 v[82:83], v20 offset:2184
    v_mfma_f32_16x16x32_bf16 v[52:55], v[136:139], v[172:175], v[52:55]
    ds_read_b64 v[84:85], v20 offset:2688
    v_mfma_f32_16x16x32_bf16 v[56:59], v[136:139], v[176:179], v[56:59]
    ds_read_b64 v[86:87], v20 offset:2696
    v_mfma_f32_16x16x32_bf16 v[60:63], v[136:139], v[180:183], v[60:63]
    ds_read_b64 v[88:89], v20 offset:3200
    v_mfma_f32_16x16x32_bf16 v[44:47], v[140:143], v[160:163], v[44:47]
    ds_read_b64 v[90:91], v20 offset:3208
    v_mfma_f32_16x16x32_bf16 v[48:51], v[140:143], v[164:167], v[48:51]
    ds_read_b64 v[92:93], v20 offset:3712
    v_mfma_f32_16x16x32_bf16 v[52:55], v[140:143], v[168:171], v[52:55]
    ds_read_b64 v[94:95], v20 offset:3720
    v_mfma_f32_16x16x32_bf16 v[56:59], v[140:143], v[172:175], v[56:59]
    v_mfma_f32_16x16x32_bf16 v[60:63], v[140:143], v[176:179], v[60:63]
    v_mfma_f32_16x16x32_bf16 v[48:51], v[144:147], v[160:163], v[48:51]
    v_mfma_f32_16x16x32_bf16 v[52:55], v[144:147], v[164:167], v[52:55]
    v_mfma_f32_16x16x32_bf16 v[56:59], v[144:147], v[168:171], v[56:59]
    v_mfma_f32_16x16x32_bf16 v[60:63], v[144:147], v[172:175], v[60:63]
    v_mfma_f32_16x16x32_bf16 v[52:55], v[148:151], v[160:163], v[52:55]
    v_mfma_f32_16x16x32_bf16 v[56:59], v[148:151], v[164:167], v[56:59]
    v_mfma_f32_16x16x32_bf16 v[60:63], v[148:151], v[168:171], v[60:63]
    v_mfma_f32_16x16x32_bf16 v[56:59], v[152:155], v[160:163], v[56:59]
    v_mfma_f32_16x16x32_bf16 v[60:63], v[152:155], v[164:167], v[60:63]
    v_mfma_f32_16x16x32_bf16 v[60:63], v[156:159], v[160:163], v[60:63]
    s_waitcnt lgkmcnt(0)
    v_mfma_f32_16x16x32_bf16 v[32:35], v[64:67], v[96:99], v[32:35]
    ds_read_b128 v[160:163], v21 offset:3776
    v_mfma_f32_16x16x32_bf16 v[36:39], v[64:67], v[100:103], v[36:39]
    ds_read_b64 v[128:129], v20 offset:192
    v_mfma_f32_16x16x32_bf16 v[40:43], v[64:67], v[104:107], v[40:43]
    ds_read_b64 v[130:131], v20 offset:200
    v_mfma_f32_16x16x32_bf16 v[44:47], v[64:67], v[108:111], v[44:47]
    ds_read_b128 v[164:167], v21 offset:3264
    v_mfma_f32_16x16x32_bf16 v[48:51], v[64:67], v[112:115], v[48:51]
    ds_read_b128 v[168:171], v21 offset:2752
    v_mfma_f32_16x16x32_bf16 v[52:55], v[64:67], v[116:119], v[52:55]
    ds_read_b128 v[172:175], v21 offset:2240
    v_mfma_f32_16x16x32_bf16 v[56:59], v[64:67], v[120:123], v[56:59]
    ds_read_b128 v[176:179], v21 offset:1728
    v_mfma_f32_16x16x32_bf16 v[60:63], v[64:67], v[124:127], v[60:63]
    ds_read_b128 v[180:183], v21 offset:1216
    v_mfma_f32_16x16x32_bf16 v[36:39], v[68:71], v[96:99], v[36:39]
    ds_read_b128 v[184:187], v21 offset:704
    v_mfma_f32_16x16x32_bf16 v[40:43], v[68:71], v[100:103], v[40:43]
    ds_read_b128 v[188:191], v21 offset:192
    v_mfma_f32_16x16x32_bf16 v[44:47], v[68:71], v[104:107], v[44:47]
    ds_read_b64 v[132:133], v20 offset:704
    v_mfma_f32_16x16x32_bf16 v[48:51], v[68:71], v[108:111], v[48:51]
    ds_read_b64 v[134:135], v20 offset:712
    v_mfma_f32_16x16x32_bf16 v[52:55], v[68:71], v[112:115], v[52:55]
    ds_read_b64 v[136:137], v20 offset:1216
    v_mfma_f32_16x16x32_bf16 v[56:59], v[68:71], v[116:119], v[56:59]
    ds_read_b64 v[138:139], v20 offset:1224
    v_mfma_f32_16x16x32_bf16 v[60:63], v[68:71], v[120:123], v[60:63]
    ds_read_b64 v[140:141], v20 offset:1728
    v_mfma_f32_16x16x32_bf16 v[40:43], v[72:75], v[96:99], v[40:43]
    ds_read_b64 v[142:143], v20 offset:1736
    v_mfma_f32_16x16x32_bf16 v[44:47], v[72:75], v[100:103], v[44:47]
    ds_read_b64 v[144:145], v20 offset:2240
    v_mfma_f32_16x16x32_bf16 v[48:51], v[72:75], v[104:107], v[48:51]
    ds_read_b64 v[146:147], v20 offset:2248
    v_mfma_f32_16x16x32_bf16 v[52:55], v[72:75], v[108:111], v[52:55]
    ds_read_b64 v[148:149], v20 offset:2752
    v_mfma_f32_16x16x32_bf16 v[56:59], v[72:75], v[112:115], v[56:59]
    ds_read_b64 v[150:151], v20 offset:2760
    v_mfma_f32_16x16x32_bf16 v[60:63], v[72:75], v[116:119], v[60:63]
    ds_read_b64 v[152:153], v20 offset:3264
    v_mfma_f32_16x16x32_bf16 v[44:47], v[76:79], v[96:99], v[44:47]
    ds_read_b64 v[154:155], v20 offset:3272
    v_mfma_f32_16x16x32_bf16 v[48:51], v[76:79], v[100:103], v[48:51]
    ds_read_b64 v[156:157], v20 offset:3776
    v_mfma_f32_16x16x32_bf16 v[52:55], v[76:79], v[104:107], v[52:55]
    ds_read_b64 v[158:159], v20 offset:3784
    v_mfma_f32_16x16x32_bf16 v[56:59], v[76:79], v[108:111], v[56:59]
    v_mfma_f32_16x16x32_bf16 v[60:63], v[76:79], v[112:115], v[60:63]
    v_mfma_f32_16x16x32_bf16 v[48:51], v[80:83], v[96:99], v[48:51]
    v_mfma_f32_16x16x32_bf16 v[52:55], v[80:83], v[100:103], v[52:55]
    v_mfma_f32_16x16x32_bf16 v[56:59], v[80:83], v[104:107], v[56:59]
    v_mfma_f32_16x16x32_bf16 v[60:63], v[80:83], v[108:111], v[60:63]
    v_mfma_f32_16x16x32_bf16 v[52:55], v[84:87], v[96:99], v[52:55]
    v_mfma_f32_16x16x32_bf16 v[56:59], v[84:87], v[100:103], v[56:59]
    v_mfma_f32_16x16x32_bf16 v[60:63], v[84:87], v[104:107], v[60:63]
    v_mfma_f32_16x16x32_bf16 v[56:59], v[88:91], v[96:99], v[56:59]
    v_mfma_f32_16x16x32_bf16 v[60:63], v[88:91], v[100:103], v[60:63]
    v_mfma_f32_16x16x32_bf16 v[60:63], v[92:95], v[96:99], v[60:63]
    s_waitcnt lgkmcnt(0)
    v_mfma_f32_16x16x32_bf16 v[32:35], v[128:131], v[160:163], v[32:35]
    v_mfma_f32_16x16x32_bf16 v[36:39], v[128:131], v[164:167], v[36:39]
    v_mfma_f32_16x16x32_bf16 v[40:43], v[128:131], v[168:171], v[40:43]
    v_mfma_f32_16x16x32_bf16 v[44:47], v[128:131], v[172:175], v[44:47]
    v_mfma_f32_16x16x32_bf16 v[48:51], v[128:131], v[176:179], v[48:51]
    v_mfma_f32_16x16x32_bf16 v[52:55], v[128:131], v[180:183], v[52:55]
    v_mfma_f32_16x16x32_bf16 v[56:59], v[128:131], v[184:187], v[56:59]
    v_mfma_f32_16x16x32_bf16 v[60:63], v[128:131], v[188:191], v[60:63]
    v_mfma_f32_16x16x32_bf16 v[36:39], v[132:135], v[160:163], v[36:39]
    v_mfma_f32_16x16x32_bf16 v[40:43], v[132:135], v[164:167], v[40:43]
    v_mfma_f32_16x16x32_bf16 v[44:47], v[132:135], v[168:171], v[44:47]
    v_mfma_f32_16x16x32_bf16 v[48:51], v[132:135], v[172:175], v[48:51]
    v_mfma_f32_16x16x32_bf16 v[52:55], v[132:135], v[176:179], v[52:55]
    v_mfma_f32_16x16x32_bf16 v[56:59], v[132:135], v[180:183], v[56:59]
    v_mfma_f32_16x16x32_bf16 v[60:63], v[132:135], v[184:187], v[60:63]
    v_mfma_f32_16x16x32_bf16 v[40:43], v[136:139], v[160:163], v[40:43]
    v_mfma_f32_16x16x32_bf16 v[44:47], v[136:139], v[164:167], v[44:47]
    v_mfma_f32_16x16x32_bf16 v[48:51], v[136:139], v[168:171], v[48:51]
    v_mfma_f32_16x16x32_bf16 v[52:55], v[136:139], v[172:175], v[52:55]
    v_mfma_f32_16x16x32_bf16 v[56:59], v[136:139], v[176:179], v[56:59]
    v_mfma_f32_16x16x32_bf16 v[60:63], v[136:139], v[180:183], v[60:63]
    v_mfma_f32_16x16x32_bf16 v[44:47], v[140:143], v[160:163], v[44:47]
    v_mfma_f32_16x16x32_bf16 v[48:51], v[140:143], v[164:167], v[48:51]
    v_mfma_f32_16x16x32_bf16 v[52:55], v[140:143], v[168:171], v[52:55]
    v_mfma_f32_16x16x32_bf16 v[56:59], v[140:143], v[172:175], v[56:59]
    v_mfma_f32_16x16x32_bf16 v[60:63], v[140:143], v[176:179], v[60:63]
    v_mfma_f32_16x16x32_bf16 v[48:51], v[144:147], v[160:163], v[48:51]
    v_mfma_f32_16x16x32_bf16 v[52:55], v[144:147], v[164:167], v[52:55]
    v_mfma_f32_16x16x32_bf16 v[56:59], v[144:147], v[168:171], v[56:59]
    v_mfma_f32_16x16x32_bf16 v[60:63], v[144:147], v[172:175], v[60:63]
    v_mfma_f32_16x16x32_bf16 v[52:55], v[148:151], v[160:163], v[52:55]
    v_mfma_f32_16x16x32_bf16 v[56:59], v[148:151], v[164:167], v[56:59]
    v_mfma_f32_16x16x32_bf16 v[60:63], v[148:151], v[168:171], v[60:63]
    v_mfma_f32_16x16x32_bf16 v[56:59], v[152:155], v[160:163], v[56:59]
    v_mfma_f32_16x16x32_bf16 v[60:63], v[152:155], v[164:167], v[60:63]
    v_mfma_f32_16x16x32_bf16 v[60:63], v[156:159], v[160:163], v[60:63]
    s_nop 7
    s_cmp_eq_u32 s59, 0
    s_cbranch_scc0 L_kg_kernel_hw1
    ds_write_b128 v24, v[48:51] offset:0
    ds_write_b128 v24, v[52:55] offset:1024
    ds_write_b128 v24, v[56:59] offset:2048
    ds_write_b128 v24, v[60:63] offset:3072
    ds_read_b64 v[64:65], v23 offset:1536
    ds_read_b64 v[66:67], v23 offset:1024
    ds_read_b64 v[68:69], v23 offset:512
    ds_read_b64 v[70:71], v23 offset:0
    s_lshl_b32 s6, s5, 2
    v_add_u32 v29, s6, v30
    v_mov_b32 v31, 1
    s_waitcnt lgkmcnt(0)
    ds_write_b32 v29, v31 offset:24
    v_xor_b32 v29, 4, v29
    v_and_b32 v96, 0xffff0000, v65
    v_lshlrev_b32 v97, 16, v65
    v_and_b32 v98, 0xffff0000, v64
    v_lshlrev_b32 v99, 16, v64
    v_and_b32 v100, 0xffff0000, v67
    v_lshlrev_b32 v101, 16, v67
    v_and_b32 v102, 0xffff0000, v66
    v_lshlrev_b32 v103, 16, v66
    v_and_b32 v104, 0xffff0000, v69
    v_lshlrev_b32 v105, 16, v69
    v_and_b32 v106, 0xffff0000, v68
    v_lshlrev_b32 v107, 16, v68
    v_and_b32 v108, 0xffff0000, v71
    v_lshlrev_b32 v109, 16, v71
    v_and_b32 v110, 0xffff0000, v70
    v_lshlrev_b32 v111, 16, v70
    v_fmac_f32 v32, v96, v13
    v_fmac_f32 v33, v97, v13
    v_fmac_f32 v34, v98, v13
    v_fmac_f32 v35, v99, v13
    v_fmac_f32 v36, v100, v13
    v_fmac_f32 v37, v101, v13
    v_fmac_f32 v38, v102, v13
    v_fmac_f32 v39, v103, v13
    v_fmac_f32 v40, v104, v13
    v_fmac_f32 v41, v105, v13
    v_fmac_f32 v42, v106, v13
    v_fmac_f32 v43, v107, v13
    v_fmac_f32 v44, v108, v13
    v_fmac_f32 v45, v109, v13
    v_fmac_f32 v46, v110, v13
    v_fmac_f32 v47, v111, v13
    s_mov_b32 s68, 0
L_kg_kernel_paira:
    ds_read_b32 v31, v29 offset:24
    s_waitcnt lgkmcnt(0)
    v_readfirstlane_b32 s69, v31
    s_cmp_ge_u32 s69, 1
    s_cbranch_scc1 L_kg_kernel_paira_ok
    s_add_u32 s68, s68, 1
    s_cmp_lt_u32 s68, 3200000
    s_cbranch_scc1 L_kg_kernel_paira
L_kg_kernel_paira_ok:
    ds_read_b128 v[80:83], v25 offset:0
    ds_read_b128 v[84:87], v25 offset:1024
    ds_read_b128 v[88:91], v25 offset:2048
    ds_read_b128 v[92:95], v25 offset:3072
    s_waitcnt lgkmcnt(0)
    v_pk_add_f32 v[32:33], v[32:33], v[80:81]
    v_pk_add_f32 v[34:35], v[34:35], v[82:83]
    v_cvt_pk_bf16_f32 v112, v32, v33
    v_cvt_pk_bf16_f32 v113, v34, v35
    v_pk_add_f32 v[36:37], v[36:37], v[84:85]
    v_pk_add_f32 v[38:39], v[38:39], v[86:87]
    v_cvt_pk_bf16_f32 v114, v36, v37
    v_cvt_pk_bf16_f32 v115, v38, v39
    s_nop 1
    v_permlane16_swap_b32 v112, v114
    v_permlane16_swap_b32 v113, v115
    buffer_store_dwordx4 v[112:115], v22, s[24:27], 0 offen offset:0 sc1
    v_pk_add_f32 v[40:41], v[40:41], v[88:89]
    v_pk_add_f32 v[42:43], v[42:43], v[90:91]
    v_cvt_pk_bf16_f32 v116, v40, v41
    v_cvt_pk_bf16_f32 v117, v42, v43
    v_pk_add_f32 v[44:45], v[44:45], v[92:93]
    v_pk_add_f32 v[46:47], v[46:47], v[94:95]
    v_cvt_pk_bf16_f32 v118, v44, v45
    v_cvt_pk_bf16_f32 v119, v46, v47
    s_nop 1
    v_permlane16_swap_b32 v116, v118
    v_permlane16_swap_b32 v117, v119
    buffer_store_dwordx4 v[116:119], v22, s[24:27], 0 offen offset:1024 sc1
    v_mov_b32 v31, 1
    s_mov_b64 exec, 1
    ds_add_u32 v30, v31 offset:44
    s_mov_b64 exec, -1
    s_waitcnt vmcnt(0)
    v_mov_b32 v31, s50
    s_mov_b64 exec, 1
    buffer_store_dword v31, v27, s[28:31], s58 offen sc1
    s_mov_b64 exec, -1
    s_branch L_kg_kernel_tail
L_kg_kernel_hw1:
    ds_write_b128 v24, v[32:35] offset:0
    ds_write_b128 v24, v[36:39] offset:1024
    ds_write_b128 v24, v[40:43] offset:2048
    ds_write_b128 v24, v[44:47] offset:3072
    ds_read_b64 v[64:65], v23 offset:1536
    ds_read_b64 v[66:67], v23 offset:1024
    ds_read_b64 v[68:69], v23 offset:512
    ds_read_b64 v[70:71], v23 offset:0
    s_lshl_b32 s6, s5, 2
    v_add_u32 v29, s6, v30
    v_mov_b32 v31, 1
    s_waitcnt lgkmcnt(0)
    ds_write_b32 v29, v31 offset:24
    v_xor_b32 v29, 4, v29
    v_and_b32 v96, 0xffff0000, v65
    v_lshlrev_b32 v97, 16, v65
    v_and_b32 v98, 0xffff0000, v64
    v_lshlrev_b32 v99, 16, v64
    v_and_b32 v100, 0xffff0000, v67
    v_lshlrev_b32 v101, 16, v67
    v_and_b32 v102, 0xffff0000, v66
    v_lshlrev_b32 v103, 16, v66
    v_and_b32 v104, 0xffff0000, v69
    v_lshlrev_b32 v105, 16, v69
    v_and_b32 v106, 0xffff0000, v68
    v_lshlrev_b32 v107, 16, v68
    v_and_b32 v108, 0xffff0000, v71
    v_lshlrev_b32 v109, 16, v71
    v_and_b32 v110, 0xffff0000, v70
    v_lshlrev_b32 v111, 16, v70
    v_fmac_f32 v48, v96, v13
    v_fmac_f32 v49, v97, v13
    v_fmac_f32 v50, v98, v13
    v_fmac_f32 v51, v99, v13
    v_fmac_f32 v52, v100, v13
    v_fmac_f32 v53, v101, v13
    v_fmac_f32 v54, v102, v13
    v_fmac_f32 v55, v103, v13
    v_fmac_f32 v56, v104, v13
    v_fmac_f32 v57, v105, v13
    v_fmac_f32 v58, v106, v13
    v_fmac_f32 v59, v107, v13
    v_fmac_f32 v60, v108, v13
    v_fmac_f32 v61, v109, v13
    v_fmac_f32 v62, v110, v13
    v_fmac_f32 v63, v111, v13
    s_mov_b32 s68, 0
L_kg_kernel_pairb:
    ds_read_b32 v31, v29 offset:24
    s_waitcnt lgkmcnt(0)
    v_readfirstlane_b32 s69, v31
    s_cmp_ge_u32 s69, 1
    s_cbranch_scc1 L_kg_kernel_pairb_ok
    s_add_u32 s68, s68, 1
    s_cmp_lt_u32 s68, 3200000
    s_cbranch_scc1 L_kg_kernel_pairb
L_kg_kernel_pairb_ok:
    ds_read_b128 v[80:83], v25 offset:0
    ds_read_b128 v[84:87], v25 offset:1024
    ds_read_b128 v[88:91], v25 offset:2048
    ds_read_b128 v[92:95], v25 offset:3072
    s_waitcnt lgkmcnt(0)
    v_pk_add_f32 v[48:49], v[48:49], v[80:81]
    v_pk_add_f32 v[50:51], v[50:51], v[82:83]
    v_cvt_pk_bf16_f32 v112, v48, v49
    v_cvt_pk_bf16_f32 v113, v50, v51
    v_pk_add_f32 v[52:53], v[52:53], v[84:85]
    v_pk_add_f32 v[54:55], v[54:55], v[86:87]
    v_cvt_pk_bf16_f32 v114, v52, v53
    v_cvt_pk_bf16_f32 v115, v54, v55
    s_nop 1
    v_permlane16_swap_b32 v112, v114
    v_permlane16_swap_b32 v113, v115
    buffer_store_dwordx4 v[112:115], v22, s[24:27], 0 offen offset:0 sc1
    v_pk_add_f32 v[56:57], v[56:57], v[88:89]
    v_pk_add_f32 v[58:59], v[58:59], v[90:91]
    v_cvt_pk_bf16_f32 v116, v56, v57
    v_cvt_pk_bf16_f32 v117, v58, v59
    v_pk_add_f32 v[60:61], v[60:61], v[92:93]
    v_pk_add_f32 v[62:63], v[62:63], v[94:95]
    v_cvt_pk_bf16_f32 v118, v60, v61
    v_cvt_pk_bf16_f32 v119, v62, v63
    s_nop 1
    v_permlane16_swap_b32 v116, v118
    v_permlane16_swap_b32 v117, v119
    buffer_store_dwordx4 v[116:119], v22, s[24:27], 0 offen offset:1024 sc1
    v_mov_b32 v31, 1
    s_mov_b64 exec, 1
    ds_add_u32 v30, v31 offset:44
    s_mov_b64 exec, -1
    s_waitcnt vmcnt(0)
    v_mov_b32 v31, s50
    s_mov_b64 exec, 1
    buffer_store_dword v31, v27, s[28:31], s58 offen sc1
    s_mov_b64 exec, -1
L_kg_kernel_tail:
    s_cmp_eq_u32 s5, 0
    s_cbranch_scc0 L_kg_kernel_ypw
    s_mov_b32 s68, 0
L_kg_kernel_yp:
    buffer_load_dword v14, v10, s[28:31], 0 offen sc1
    buffer_load_dword v15, v11, s[28:31], 0 offen sc1
    s_waitcnt vmcnt(0)
    v_cmp_eq_u32 vcc, s50, v14
    v_cmp_eq_u32 s[6:7], s50, v15
    s_nop 1
    s_and_b64 vcc, vcc, s[6:7]
    s_cmp_eq_u64 vcc, -1
    s_cbranch_scc1 L_kg_kernel_yp_ok
    s_sleep 2
    s_add_u32 s68, s68, 1
    s_cmp_lt_u32 s68, 200000
    s_cbranch_scc1 L_kg_kernel_yp
L_kg_kernel_yp_ok:
    v_mov_b32 v31, 1
    ds_write_b32 v30, v31 offset:40
    s_branch L_kg_kernel_ygo
L_kg_kernel_ypw:
    s_mov_b32 s68, 0
L_kg_kernel_yw:
    ds_read_b32 v31, v30 offset:40
    s_waitcnt lgkmcnt(0)
    v_readfirstlane_b32 s69, v31
    s_cmp_ge_u32 s69, 1
    s_cbranch_scc1 L_kg_kernel_yw_ok
    s_sleep 1
    s_add_u32 s68, s68, 1
    s_cmp_lt_u32 s68, 3200000
    s_cbranch_scc1 L_kg_kernel_yw
L_kg_kernel_yw_ok:
L_kg_kernel_ygo:
    buffer_load_dword v208, v5, s[20:23], 0 offen sc1
    s_mov_b32 m0, s57
    v_lshlrev_b32 v14, 3, v1
    buffer_load_dwordx4 v8, s[12:15], 0 offen sc1 lds
    s_add_u32 m0, s57, 1024
    v_add_u32 v14, s57, v14
    buffer_load_dwordx4 v9, s[12:15], 0 offen sc1 lds
    v_lshlrev_b32 v64, 16, v192
    v_and_b32 v65, 0xffff0000, v192
    v_lshlrev_b32 v80, 16, v200
    v_and_b32 v81, 0xffff0000, v200
    v_lshlrev_b32 v66, 16, v193
    v_and_b32 v67, 0xffff0000, v193
    v_lshlrev_b32 v82, 16, v201
    v_and_b32 v83, 0xffff0000, v201
    v_lshlrev_b32 v68, 16, v194
    v_and_b32 v69, 0xffff0000, v194
    v_lshlrev_b32 v84, 16, v202
    v_and_b32 v85, 0xffff0000, v202
    v_lshlrev_b32 v70, 16, v195
    v_and_b32 v71, 0xffff0000, v195
    v_lshlrev_b32 v86, 16, v203
    v_and_b32 v87, 0xffff0000, v203
    v_lshlrev_b32 v72, 16, v196
    v_and_b32 v73, 0xffff0000, v196
    v_lshlrev_b32 v88, 16, v204
    v_and_b32 v89, 0xffff0000, v204
    v_lshlrev_b32 v74, 16, v197
    v_and_b32 v75, 0xffff0000, v197
    v_lshlrev_b32 v90, 16, v205
    v_and_b32 v91, 0xffff0000, v205
    v_lshlrev_b32 v76, 16, v198
    v_and_b32 v77, 0xffff0000, v198
    v_lshlrev_b32 v92, 16, v206
    v_and_b32 v93, 0xffff0000, v206
    v_lshlrev_b32 v78, 16, v199
    v_and_b32 v79, 0xffff0000, v199
    v_lshlrev_b32 v94, 16, v207
    v_and_b32 v95, 0xffff0000, v207
    v_add_u32 v15, s57, v4
    v_lshlrev_b32 v16, 2, v1
    v_add_u32 v16, s57, v16
    s_waitcnt vmcnt(2)
    v_sub_f32 v209, 1.0, v208
    v_mul_f32 v64, v208, v64
    v_mul_f32 v80, v209, v80
    v_mul_f32 v65, v208, v65
    v_mul_f32 v81, v209, v81
    v_mul_f32 v66, v208, v66
    v_mul_f32 v82, v209, v82
    v_mul_f32 v67, v208, v67
    v_mul_f32 v83, v209, v83
    v_mul_f32 v68, v208, v68
    v_mul_f32 v84, v209, v84
    v_mul_f32 v69, v208, v69
    v_mul_f32 v85, v209, v85
    v_mul_f32 v70, v208, v70
    v_mul_f32 v86, v209, v86
    v_mul_f32 v71, v208, v71
    v_mul_f32 v87, v209, v87
    v_mul_f32 v72, v208, v72
    v_mul_f32 v88, v209, v88
    v_mul_f32 v73, v208, v73
    v_mul_f32 v89, v209, v89
    v_mul_f32 v74, v208, v74
    v_mul_f32 v90, v209, v90
    v_mul_f32 v75, v208, v75
    v_mul_f32 v91, v209, v91
    v_mul_f32 v76, v208, v76
    v_mul_f32 v92, v209, v92
    v_mul_f32 v77, v208, v77
    v_mul_f32 v93, v209, v93
    v_mul_f32 v78, v208, v78
    v_mul_f32 v94, v209, v94
    v_mul_f32 v79, v208, v79
    v_mul_f32 v95, v209, v95
    ds_write_b32 v16, v209 offset:6144
    s_waitcnt vmcnt(0)
    ds_read_b64_tr_b16 v[96:97], v14 offset:0
    ds_read_b64_tr_b16 v[98:99], v14 offset:512
    ds_read_b64_tr_b16 v[100:101], v14 offset:1024
    ds_read_b64_tr_b16 v[102:103], v14 offset:1536
    s_waitcnt lgkmcnt(3)
    v_lshlrev_b32 v112, 16, v96
    v_and_b32 v113, 0xffff0000, v96
    v_lshlrev_b32 v114, 16, v97
    v_and_b32 v115, 0xffff0000, v97
    v_fma_f32 v80, v64, v112, v80
    v_fma_f32 v81, v65, v113, v81
    v_fma_f32 v82, v66, v114, v82
    v_fma_f32 v83, v67, v115, v83
    s_waitcnt lgkmcnt(2)
    v_lshlrev_b32 v116, 16, v98
    v_and_b32 v117, 0xffff0000, v98
    v_lshlrev_b32 v118, 16, v99
    v_and_b32 v119, 0xffff0000, v99
    v_fma_f32 v84, v68, v116, v84
    v_fma_f32 v85, v69, v117, v85
    v_fma_f32 v86, v70, v118, v86
    v_fma_f32 v87, v71, v119, v87
    s_waitcnt lgkmcnt(1)
    v_lshlrev_b32 v120, 16, v100
    v_and_b32 v121, 0xffff0000, v100
    v_lshlrev_b32 v122, 16, v101
    v_and_b32 v123, 0xffff0000, v101
    v_fma_f32 v88, v72, v120, v88
    v_fma_f32 v89, v73, v121, v89
    v_fma_f32 v90, v74, v122, v90
    v_fma_f32 v91, v75, v123, v91
    s_waitcnt lgkmcnt(0)
    v_lshlrev_b32 v124, 16, v102
    v_and_b32 v125, 0xffff0000, v102
    v_lshlrev_b32 v126, 16, v103
    v_and_b32 v127, 0xffff0000, v103
    v_fma_f32 v92, v76, v124, v92
    v_fma_f32 v93, v77, v125, v93
    v_fma_f32 v94, v78, v126, v94
    v_fma_f32 v95, v79, v127, v95
    ds_write_b128 v15, v[80:83] offset:2048
    ds_write_b128 v15, v[84:87] offset:3072
    ds_write_b128 v15, v[88:91] offset:4096
    ds_write_b128 v15, v[92:95] offset:5120
    s_waitcnt lgkmcnt(0)
    s_endpgm
L_kg_kernel_gate:
    s_lshl_b32 s6, s3, 2
    s_add_u32 s6, s6, s4
    s_sub_u32 s6, s6, 28
    s_lshl_b32 s6, s6, 6
    s_lshl_b32 s7, s5, 4
    s_add_u32 s48, s6, s7
    s_lshl_b32 s6, s48, 10
    v_add_u32 v20, s6, v4
    buffer_load_dwordx4 v[144:147], v4, s[12:15], 0 offen
    buffer_load_dwordx4 v[64:67], v20, s[8:11], 0 offen offset:0
    buffer_load_dwordx4 v[68:71], v20, s[8:11], 0 offen offset:1024
    buffer_load_dwordx4 v[72:75], v20, s[8:11], 0 offen offset:2048
    buffer_load_dwordx4 v[76:79], v20, s[8:11], 0 offen offset:3072
    v_add_u32 v20, 4096, v20
    buffer_load_dwordx4 v[80:83], v20, s[8:11], 0 offen offset:0
    buffer_load_dwordx4 v[84:87], v20, s[8:11], 0 offen offset:1024
    buffer_load_dwordx4 v[88:91], v20, s[8:11], 0 offen offset:2048
    buffer_load_dwordx4 v[92:95], v20, s[8:11], 0 offen offset:3072
    v_add_u32 v20, 4096, v20
    buffer_load_dwordx4 v[96:99], v20, s[8:11], 0 offen offset:0
    buffer_load_dwordx4 v[100:103], v20, s[8:11], 0 offen offset:1024
    buffer_load_dwordx4 v[104:107], v20, s[8:11], 0 offen offset:2048
    buffer_load_dwordx4 v[108:111], v20, s[8:11], 0 offen offset:3072
    v_add_u32 v20, 4096, v20
    buffer_load_dwordx4 v[112:115], v20, s[8:11], 0 offen offset:0
    buffer_load_dwordx4 v[116:119], v20, s[8:11], 0 offen offset:1024
    buffer_load_dwordx4 v[120:123], v20, s[8:11], 0 offen offset:2048
    buffer_load_dwordx4 v[124:127], v20, s[8:11], 0 offen offset:3072
    buffer_load_dword v28, v27, s[32:35], 0 offen sc1
    v_sub_u32 v14, 15, v2
    v_and_b32 v15, 3, v14
    v_lshrrev_b32 v14, 2, v14
    v_mul_u32_u24 v15, 4160, v15
    v_lshlrev_b32 v14, 3, v14
    v_sub_u32 v15, v15, v14
    v_lshlrev_b32 v14, 4, v3
    v_add_u32 v15, v15, v14
    s_lshl_b32 s67, s59, 8
    s_add_u32 s6, s61, s67
    s_add_u32 s6, s6, 32
    v_add_u32 v20, s6, v15
    v_lshlrev_b32 v15, 5, v2
    v_sub_u32 v16, v14, v15
    s_add_u32 s6, s62, 480
    s_add_u32 s6, s6, s67
    v_add_u32 v21, s6, v16
    v_lshlrev_b32 v16, 3, v3
    v_add_u32 v16, v16, v15
    s_lshl_b32 s67, s59, 11
    v_lshrrev_b32 v22, 1, v3
    v_lshlrev_b32 v22, 4, v22
    v_add_u32 v22, v22, v15
    v_and_b32 v23, 1, v3
    v_lshlrev_b32 v23, 9, v23
    v_add_u32 v22, v22, v23
    v_add_u32 v22, s67, v22
    s_add_u32 s6, s62, 2552
    s_sub_u32 s6, s6, s67
    v_sub_u32 v23, s6, v16
    s_lshl_b32 s6, s5, 12
    s_add_u32 s6, s6, 131584
    v_add_u32 v24, s6, v4
    s_xor_b32 s6, s5, 1
    s_lshl_b32 s6, s6, 12
    s_add_u32 s6, s6, 131584
    v_add_u32 v25, s6, v4
    v_mov_b32 v27, 0
    v_add_u32 v5, s56, v2
    v_lshlrev_b32 v6, 10, v5
    v_lshlrev_b32 v7, 3, v3
    s_lshl_b32 s6, s53, 7
    v_add_u32 v7, s6, v7
    v_add_u32 v6, v6, v7
    v_lshlrev_b32 v5, 2, v5
    v_lshrrev_b32 v8, 1, v1
    v_lshlrev_b32 v8, 12, v8
    v_and_b32 v9, 1, v1
    v_lshlrev_b32 v9, 4, v9
    v_add_u32 v8, v8, v9
    s_lshl_b32 s6, s53, 18
    s_lshl_b32 s7, s56, 1
    s_add_u32 s6, s6, s7
    v_add_u32 v8, s6, v8
    v_add_u32 v9, 0x20000, v8
    s_lshl_b32 s6, s53, 1
    s_lshr_b32 s7, s52, 4
    s_add_u32 s6, s6, s7
    s_lshl_b32 s6, s6, 12
    s_add_u32 s6, s6, 65536
    v_lshrrev_b32 v10, 1, v1
    v_lshlrev_b32 v10, 7, v10
    v_and_b32 v11, 1, v1
    v_lshlrev_b32 v11, 2, v11
    v_add_u32 v10, v10, v11
    v_add_u32 v10, s6, v10
    s_lshl_b32 s6, s52, 7
    s_add_u32 s6, s6, 131072
    v_and_b32 v11, 3, v1
    v_lshlrev_b32 v11, 2, v11
    v_add_u32 v11, s6, v11
    s_lshl_b32 s6, s5, 1
    s_sub_u32 s6, 32, s6
    v_add_u32 v32, s6, v4
    v_add_u32 v33, 4096, v32
    v_and_b32 v34, 31, v1
    s_add_u32 s6, s5, 16
    v_subrev_u32 v35, s6, v34
    v_lshlrev_b32 v35, 1, v35
    v_lshrrev_b32 v36, 5, v1
    v_lshlrev_b32 v37, 12, v36
    v_add_u32 v37, v37, v35
    v_cmp_gt_i32 vcc, 0, v35
    v_mov_b32 v38, 0x7fffffff
    s_mul_i32 s6, s5, 4160
    v_cndmask_b32 v35, v37, v38, vcc
    v_lshlrev_b32 v34, 1, v34
    v_add_u32 v34, s6, v34
    v_mul_u32_u24 v36, 16640, v36
    v_sub_u32 v36, 16640, v36
    v_add_u32 v34, v34, v36
    s_lshl_b32 s6, s5, 10
    v_add_u32 v36, s6, v4
    v_add_u32 v37, 4096, v36
    v_and_b32 v39, 31, v1
    v_lshlrev_b32 v39, 7, v39
    s_lshl_b32 s6, s3, 12
    s_lshr_b32 s7, s4, 3
    s_lshl_b32 s7, s7, 2
    s_add_u32 s6, s6, s7
    s_add_u32 s6, s6, 32768
    v_add_u32 v39, s6, v39
    s_lshr_b32 s6, s5, 1
    s_mul_i32 s6, s6, 4608
    s_and_b32 s7, s5, 1
    s_lshl_b32 s7, s7, 8
    s_add_u32 s6, s6, s7
    s_add_u32 s6, s6, 158464
    v_lshlrev_b32 v41, 2, v1
    v_add_u32 v41, s6, v41
    s_waitcnt vmcnt(0)
    v_dot2_f32_bf16 v128, v64, v144, 0
    v_dot2_f32_bf16 v129, v68, v144, 0
    v_dot2_f32_bf16 v130, v72, v144, 0
    v_dot2_f32_bf16 v131, v76, v144, 0
    v_dot2_f32_bf16 v132, v80, v144, 0
    v_dot2_f32_bf16 v133, v84, v144, 0
    v_dot2_f32_bf16 v134, v88, v144, 0
    v_dot2_f32_bf16 v135, v92, v144, 0
    v_dot2_f32_bf16 v136, v96, v144, 0
    v_dot2_f32_bf16 v137, v100, v144, 0
    v_dot2_f32_bf16 v138, v104, v144, 0
    v_dot2_f32_bf16 v139, v108, v144, 0
    v_dot2_f32_bf16 v140, v112, v144, 0
    v_dot2_f32_bf16 v141, v116, v144, 0
    v_dot2_f32_bf16 v142, v120, v144, 0
    v_dot2_f32_bf16 v143, v124, v144, 0
    v_dot2_f32_bf16 v128, v65, v145, v128
    v_dot2_f32_bf16 v129, v69, v145, v129
    v_dot2_f32_bf16 v130, v73, v145, v130
    v_dot2_f32_bf16 v131, v77, v145, v131
    v_dot2_f32_bf16 v132, v81, v145, v132
    v_dot2_f32_bf16 v133, v85, v145, v133
    v_dot2_f32_bf16 v134, v89, v145, v134
    v_dot2_f32_bf16 v135, v93, v145, v135
    v_dot2_f32_bf16 v136, v97, v145, v136
    v_dot2_f32_bf16 v137, v101, v145, v137
    v_dot2_f32_bf16 v138, v105, v145, v138
    v_dot2_f32_bf16 v139, v109, v145, v139
    v_dot2_f32_bf16 v140, v113, v145, v140
    v_dot2_f32_bf16 v141, v117, v145, v141
    v_dot2_f32_bf16 v142, v121, v145, v142
    v_dot2_f32_bf16 v143, v125, v145, v143
    v_dot2_f32_bf16 v128, v66, v146, v128
    v_dot2_f32_bf16 v129, v70, v146, v129
    v_dot2_f32_bf16 v130, v74, v146, v130
    v_dot2_f32_bf16 v131, v78, v146, v131
    v_dot2_f32_bf16 v132, v82, v146, v132
    v_dot2_f32_bf16 v133, v86, v146, v133
    v_dot2_f32_bf16 v134, v90, v146, v134
    v_dot2_f32_bf16 v135, v94, v146, v135
    v_dot2_f32_bf16 v136, v98, v146, v136
    v_dot2_f32_bf16 v137, v102, v146, v137
    v_dot2_f32_bf16 v138, v106, v146, v138
    v_dot2_f32_bf16 v139, v110, v146, v139
    v_dot2_f32_bf16 v140, v114, v146, v140
    v_dot2_f32_bf16 v141, v118, v146, v141
    v_dot2_f32_bf16 v142, v122, v146, v142
    v_dot2_f32_bf16 v143, v126, v146, v143
    v_dot2_f32_bf16 v128, v67, v147, v128
    v_dot2_f32_bf16 v129, v71, v147, v129
    v_dot2_f32_bf16 v130, v75, v147, v130
    v_dot2_f32_bf16 v131, v79, v147, v131
    v_dot2_f32_bf16 v132, v83, v147, v132
    v_dot2_f32_bf16 v133, v87, v147, v133
    v_dot2_f32_bf16 v134, v91, v147, v134
    v_dot2_f32_bf16 v135, v95, v147, v135
    v_dot2_f32_bf16 v136, v99, v147, v136
    v_dot2_f32_bf16 v137, v103, v147, v137
    v_dot2_f32_bf16 v138, v107, v147, v138
    v_dot2_f32_bf16 v139, v111, v147, v139
    v_dot2_f32_bf16 v140, v115, v147, v140
    v_dot2_f32_bf16 v141, v119, v147, v141
    v_dot2_f32_bf16 v142, v123, v147, v142
    v_dot2_f32_bf16 v143, v127, v147, v143
    s_nop 2
    v_permlane32_swap_b32 v128, v136
    v_permlane32_swap_b32 v129, v137
    v_permlane32_swap_b32 v130, v138
    v_permlane32_swap_b32 v131, v139
    v_permlane32_swap_b32 v132, v140
    v_permlane32_swap_b32 v133, v141
    v_permlane32_swap_b32 v134, v142
    v_permlane32_swap_b32 v135, v143
    v_add_f32 v128, v128, v136
    v_add_f32 v129, v129, v137
    v_add_f32 v130, v130, v138
    v_add_f32 v131, v131, v139
    v_add_f32 v132, v132, v140
    v_add_f32 v133, v133, v141
    v_add_f32 v134, v134, v142
    v_add_f32 v135, v135, v143
    s_nop 1
    v_permlane16_swap_b32 v128, v132
    v_permlane16_swap_b32 v129, v133
    v_permlane16_swap_b32 v130, v134
    v_permlane16_swap_b32 v131, v135
    v_add_f32 v128, v128, v132
    v_add_f32 v129, v129, v133
    v_add_f32 v130, v130, v134
    v_add_f32 v131, v131, v135
    s_nop 1
    v_add_f32_dpp v128, v128, v128 row_ror:8 row_mask:0xf bank_mask:0xf
    v_add_f32_dpp v129, v129, v129 row_ror:8 row_mask:0xf bank_mask:0xf
    v_add_f32_dpp v130, v130, v130 row_ror:8 row_mask:0xf bank_mask:0xf
    v_add_f32_dpp v131, v131, v131 row_ror:8 row_mask:0xf bank_mask:0xf
    s_nop 1
    v_add_f32_dpp v128, v128, v128 row_ror:4 row_mask:0xf bank_mask:0xf
    v_add_f32_dpp v129, v129, v129 row_ror:4 row_mask:0xf bank_mask:0xf
    v_add_f32_dpp v130, v130, v130 row_ror:4 row_mask:0xf bank_mask:0xf
    v_add_f32_dpp v131, v131, v131 row_ror:4 row_mask:0xf bank_mask:0xf
    s_nop 1
    v_add_f32_dpp v128, v128, v128 row_ror:2 row_mask:0xf bank_mask:0xf
    v_add_f32_dpp v129, v129, v129 row_ror:2 row_mask:0xf bank_mask:0xf
    v_add_f32_dpp v130, v130, v130 row_ror:2 row_mask:0xf bank_mask:0xf
    v_add_f32_dpp v131, v131, v131 row_ror:2 row_mask:0xf bank_mask:0xf
    s_nop 1
    v_add_f32_dpp v128, v128, v128 row_ror:1 row_mask:0xf bank_mask:0xf
    v_add_f32_dpp v129, v129, v129 row_ror:1 row_mask:0xf bank_mask:0xf
    v_add_f32_dpp v130, v130, v130 row_ror:1 row_mask:0xf bank_mask:0xf
    v_add_f32_dpp v131, v131, v131 row_ror:1 row_mask:0xf bank_mask:0xf
    v_cmp_eq_u32 vcc, 1, v2
    s_nop 1
    v_cndmask_b32 v128, v128, v129, vcc
    v_cmp_eq_u32 vcc, 2, v2
    s_nop 1
    v_cndmask_b32 v128, v128, v130, vcc
    v_cmp_eq_u32 vcc, 3, v2
    s_nop 1
    v_cndmask_b32 v128, v128, v131, vcc
    v_mul_f32 v128, 0xbfb8aa3b, v128
    v_exp_f32 v128, v128
    v_and_b32 v148, 1, v3
    v_lshlrev_b32 v148, 2, v148
    v_add_f32 v128, 1.0, v128
    v_rcp_f32 v128, v128
    v_lshrrev_b32 v149, 1, v3
    v_lshlrev_b32 v149, 3, v149
    v_add_u32 v148, v148, v149
    v_add_u32 v148, v148, v2
    v_add_u32 v148, s48, v148
    v_lshlrev_b32 v148, 2, v148
    v_cmp_gt_u32 vcc, 4, v2
    s_and_saveexec_b64 s[6:7], vcc
    buffer_store_dword v128, v148, s[20:23], 0 offen sc1
    s_mov_b64 exec, -1
    s_lshl_b32 s6, s3, 2
    s_add_u32 s6, s6, s4
    s_sub_u32 s6, s6, 28
    s_lshl_b32 s6, s6, 7
    s_lshl_b32 s7, s5, 2
    s_add_u32 s6, s6, s7
    s_add_u32 s67, s6, 131072
    v_readfirstlane_b32 s50, v28
    s_cmp_lg_u32 s50, 0
    s_cbranch_scc1 L_kg_kernel_nag_ok
    s_mov_b32 s68, 0
L_kg_kernel_nag:
    buffer_load_dword v28, v27, s[32:35], 0 offen sc1
    s_waitcnt vmcnt(0)
    v_readfirstlane_b32 s50, v28
    s_cmp_lg_u32 s50, 0
    s_cbranch_scc1 L_kg_kernel_nag_ok
    s_add_u32 s68, s68, 1
    s_cmp_lt_u32 s68, 200000
    s_cbranch_scc1 L_kg_kernel_nag
L_kg_kernel_nag_ok:
    s_waitcnt vmcnt(0)
    v_mov_b32 v31, s50
    s_mov_b64 exec, 1
    buffer_store_dword v31, v27, s[28:31], s67 offen sc1
    s_mov_b64 exec, -1
    s_branch L_kg_kernel_cs
L_kg_kernel_end:
    s_endpgm

.section .rodata,"a"
.p2align 6
.amdhsa_kernel kg_kernel
  .amdhsa_next_free_vgpr 256
  .amdhsa_next_free_sgpr 102
  .amdhsa_accum_offset 256
  .amdhsa_group_segment_fixed_size 0
  .amdhsa_kernarg_size 120
  .amdhsa_user_sgpr_count 2
  .amdhsa_user_sgpr_kernarg_segment_ptr 1
  .amdhsa_system_sgpr_workgroup_id_x 1
.end_amdhsa_kernel
```
